```python
import torch

def _softmax(x, axis=-1):
    return torch.softmax(x, dim=axis)
def _gelu(x):
    return torch.nn.functional.gelu(x, approximate="tanh")
def _silu(x):
    return torch.nn.functional.silu(x)
def _sigmoid(x):
    return torch.sigmoid(x)
def _layernorm(x, axis=-1, eps=1e-5):
    m = x.mean(dim=axis, keepdim=True)
    v = x.var(dim=axis, keepdim=True, unbiased=False)
    return (x - m) / torch.sqrt(v + eps)
def _scatter_add(tgt, idx, src, axis=0):
    return tgt.clone().index_add_(axis, idx, src)
def _segment_sum(src, seg, n):
    out = torch.zeros((n,) + src.shape[1:], dtype=src.dtype)
    return out.index_add_(0, seg, src)
def _pad(x, pw):
    flat = tuple(v for pair in reversed(pw) for v in pair)
    return torch.nn.functional.pad(x, flat)

kernel_name = 'gated_mix__ssm_conv_s4d__dense_activation_silu__prompt'

def setup_inputs():

    _w = (lambda a: (lambda t: t.to(torch.bfloat16) if t.is_floating_point() else t)(torch.as_tensor(a)))
    def _A_setup():
        Bsz, L, D, N = 1, 2048, 512, 128
        return {
            "u": _w((lambda *s: torch.randn(*s, dtype=torch.bfloat16) * 0.05)(Bsz, L, D)),
            "log_A_real": _w((lambda *s: torch.randn(*s, dtype=torch.bfloat16) * 6.4)(D, N) * 0.5),
            "A_imag": _w((lambda *s: torch.randn(*s, dtype=torch.bfloat16) * 0.05)(D, N) * 3.14),
            "C_real": _w((lambda *s: torch.randn(*s, dtype=torch.bfloat16) * 0.2)(D, N) / N ** 0.5),
            "C_imag": _w((lambda *s: torch.randn(*s, dtype=torch.bfloat16) * 0.2)(D, N) / N ** 0.5),
            "log_dt": _w((lambda *s: torch.randn(*s, dtype=torch.bfloat16) * 0.05)(D) * 0.5 - 4.0),
            "D_skip": _w((lambda *s: torch.randn(*s, dtype=torch.bfloat16) * 0.05)(D)),
        }
    _A_in = _A_setup()

    def _B_setup():
        B, S, D, F = 1, 2048, 512, 1792
        return {
            "x": _w((lambda *s: torch.randn(*s, dtype=torch.bfloat16) * 0.05)(B, S, D)),
            "w1": _w((lambda *s: torch.randn(*s, dtype=torch.bfloat16) * 6.4)(D, F) * (D ** -0.5)),
            "w2": _w((lambda *s: torch.randn(*s, dtype=torch.bfloat16) * 0.2)(F, D) * (F ** -0.5)),
        }
    _B_in = _B_setup()

    return {
        "A_u": _A_in["u"],
        "A_log_A_real": _A_in["log_A_real"],
        "A_A_imag": _A_in["A_imag"],
        "A_C_real": _A_in["C_real"],
        "A_C_imag": _A_in["C_imag"],
        "A_log_dt": _A_in["log_dt"],
        "A_D_skip": _A_in["D_skip"],
        "B_x": _B_in["x"],
        "B_w1": _B_in["w1"],
        "B_w2": _B_in["w2"],
        "gate_w": _w((lambda *s: torch.randn(*s, dtype=torch.bfloat16) * 0.05)(512) * 16.0),
    }

def reference(A_u, A_log_A_real, A_A_imag, A_C_real, A_C_imag, A_log_dt, A_D_skip, B_x, B_w1, B_w2, gate_w):
    def _A_ref(u, log_A_real, A_imag, C_real, C_imag, log_dt, D_skip):
        L = u.shape[1]
        dt = torch.exp(log_dt)
        A = -torch.exp(log_A_real) + 1j * A_imag
        C = (C_real + 1j * C_imag) * dt[:, None]
        pos = (lambda x, dt: x.to(dt))(torch.arange(L), log_dt.dtype)
        P = torch.exp((A * dt[:, None])[:, :, None] * pos[None, None, :])
        K = 2.0 * torch.einsum("dn,dnl->dl", C, P).real
        L2 = 2 * L
        u_t = (lambda x, *d: x.permute(*d))(u, 0, 2, 1)
        Kf = (lambda x, *a, **k: torch.fft.rfft(x.float(), *a, **k))(K, L2)
        Uf = (lambda x, *a, **k: torch.fft.rfft(x.float(), *a, **k))(u_t, L2)
        y = (lambda x, *a, **k: torch.fft.irfft(x, *a, **k).to(torch.bfloat16))(Uf * Kf[None, :, :], L2)[:, :, :L]
        y = (lambda x, *d: x.permute(*d))(y, 0, 2, 1)
        return y + u * D_skip[None, None, :]

    def _B_ref(x, w1, w2):
        h = torch.einsum("bsd,df->bsf", x, w1)
        h = _silu(h)
        out = torch.einsum("bsf,fd->bsd", h, w2)
        return out

    x = A_u
    g = _sigmoid((x * gate_w).sum(-1, keepdims=True))
    a = _A_ref(x, A_log_A_real, A_A_imag, A_C_real, A_C_imag, A_log_dt, A_D_skip)
    b = _B_ref(x, B_w1, B_w2)
    return g * a + (1 - g) * b
```

```asm
; @launch grid=(256,1,1) block=(256,1,1) lds=163840
.amdgcn_target "amdgcn-amd-amdhsa--gfx950"
.text
.globl gated_mix__ssm_conv_s4d__dense_activation_silu__prompt_kernel
.p2align 8
.type gated_mix__ssm_conv_s4d__dense_activation_silu__prompt_kernel,@function
gated_mix__ssm_conv_s4d__dense_activation_silu__prompt_kernel:
    s_cmp_ge_u32 s2, 256
    s_cbranch_scc1 L_end
    s_load_dwordx16 s[32:47], s[0:1], 0
    s_load_dwordx16 s[8:23], s[0:1], 64
    v_and_b32 v1, 63, v0
    v_lshrrev_b32 v64, 6, v0
    s_and_b32 s61, s2, 7
    v_readfirstlane_b32 s60, v64
    s_lshr_b32 s62, s2, 3
    s_getpc_b64 s[28:29]
L_pc:
    s_lshl_b32 s30, s62, 3
    v_and_b32 v65, 7, v1
    v_add_u32 v65, s30, v65
    v_lshl_add_u32 v65, v64, 8, v65
    v_lshlrev_b32 v65, 7, v65
    v_min_u32 v65, L_end-L_pc, v65
    s_mov_b64 exec, 0xff
    global_load_dword v63, v65, s[28:29]
    s_mov_b64 exec, -1
    v_lshlrev_b32 v2, 4, v1
    v_mov_b32 v26, 0
    s_lshl_b32 s30, s2, 9
    v_lshl_add_u32 v72, v0, 1, s30
    v_mov_b32 v64, 0
    v_mov_b32 v65, 0
    v_mov_b32 v66, 0
    v_mov_b32 v67, 0
    s_and_b32 s30, s62, 3
    s_lshl_b32 s31, s61, 2
    s_add_u32 s64, s30, s31
    s_lshr_b32 s65, s62, 2
    s_lshl_b32 s92, s60, 12
    s_mov_b32 s6, 0x200000
    s_mov_b32 s7, 0x20000
    s_cmp_ge_u32 s62, 28
    s_cbranch_scc1 L_hpro
    s_lshr_b32 s31, s61, 1
    s_lshl_b32 s31, s31, 2
    s_add_u32 s31, s31, s30
    s_and_b32 s3, s61, 1
    s_mul_i32 s3, s3, 7
    s_add_u32 s3, s3, s65
    s_lshl_b32 s28, s30, 1
    s_add_u32 s28, s28, s65
    s_cmp_eq_u32 s65, 3
    s_cmov_b32 s65, 7
    s_and_b32 s28, s28, 7
    s_lshl_b32 s76, s28, 7
    s_mul_i32 s84, s28, 229376
    s_lshl_b32 s28, s31, 2
    s_add_u32 s28, s28, s60
    s_lshl_b32 s28, s28, 15
    s_lshl_b32 s29, s3, 8
    s_mul_i32 s30, s60, 57344
    s_add_u32 s29, s29, s30
    v_lshrrev_b32 v68, 3, v1
    v_and_b32 v69, 2, v68
    v_lshlrev_b32 v69, 2, v69
    v_lshrrev_b32 v70, 2, v68
    v_lshl_add_u32 v69, v70, 1, v69
    v_and_b32 v70, 1, v68
    v_add_u32 v69, v69, v70
    v_lshrrev_b32 v70, 1, v68
    v_and_b32 v71, 7, v1
    v_xor_b32 v70, v70, v71
    v_lshl_add_u32 v70, v70, 4, s28
    v_lshl_add_u32 v3, v69, 10, v70
    v_xor_b32 v69, 64, v3
    v_add_u32 v4, 3072, v69
    v_add_u32 v5, 14336, v3
    v_add_u32 v6, 17408, v69
    v_lshrrev_b32 v68, 4, v1
    v_lshlrev_b32 v69, 2, v68
    v_and_b32 v70, 15, v1
    v_xor_b32 v69, v69, v70
    v_lshl_add_u32 v69, v69, 4, s29
    v_mul_u32_u24 v68, 3584, v68
    v_add_u32 v7, v68, v69
    v_add_u32 v8, 13312, v7
    v_add_u32 v9, 26624, v7
    v_add_u32 v10, 39936, v7
    s_add_u32 s77, s76, 128
    s_and_b32 s77, s77, 1023
    s_mul_i32 s85, s77, 1792
    s_lshl_b32 s30, s2, 2
    s_waitcnt lgkmcnt(0)
    global_load_short_d16_hi v64, v72, s[34:35]
    global_load_short_d16_hi v65, v72, s[36:37]
    global_load_short_d16_hi v66, v72, s[38:39]
    global_load_short_d16_hi v67, v72, s[40:41]
    s_load_dword s72, s[42:43], s30
    s_load_dword s73, s[44:45], s30
    s_load_dword s63, s[18:19], 8192
    s_mov_b64 s[4:5], s[32:33]
    s_mov_b64 s[50:51], s[10:11]
    s_mov_b32 s10, 0x1c0000
    s_mov_b32 s11, 0x20000
    s_add_u32 m0, s92, 35840
    s_nop 0
    buffer_load_dwordx4 v3, s[4:7], s76 offen offset:0 lds
    buffer_load_dwordx4 v4, s[4:7], s76 offen offset:1024 lds
    buffer_load_dwordx4 v5, s[4:7], s76 offen offset:2048 lds
    s_mov_b64 s[20:21], s[14:15]
    s_mov_b64 s[24:25], s[16:17]
    s_mov_b64 s[16:17], s[18:19]
    s_mov_b64 s[12:13], s[50:51]
    s_mov_b32 s14, 0x1c0000
    s_mov_b32 s15, 0x20000
    s_mov_b32 s18, 16777216
    s_mov_b32 s19, 0x20000
    s_mov_b32 s22, 0x200000
    s_mov_b32 s23, 0x20000
    s_mov_b32 s26, 256
    s_mov_b32 s27, 0x20000
    s_and_b32 s30, s60, 1
    s_lshl_b32 s31, s31, 1
    s_add_u32 s31, s31, s30
    s_lshr_b32 s30, s60, 1
    s_lshl_b32 s3, s3, 1
    buffer_load_dwordx4 v6, s[4:7], s76 offen offset:3072 lds
    s_add_u32 s3, s3, s30
    s_mul_i32 s28, s31, 112
    s_lshl_b32 s30, s3, 2
    s_add_u32 s28, s28, s30
    s_lshl_b32 s28, s28, 11
    s_add_u32 s28, s28, 5242880
    v_add_u32 v62, s28, v2
    s_mul_i32 s28, s3, 37
    s_lshr_b32 s28, s28, 8
    s_mul_i32 s29, s28, 228
    s_add_u32 s29, s29, s30
    s_lshl_b32 s74, s31, 10
    s_add_u32 s74, s74, s29
    s_add_u32 s74, s74, 32768
    s_add_u32 s78, s77, 128
    s_and_b32 s78, s78, 1023
    s_add_u32 m0, s92, 52224
    s_nop 0
    buffer_load_dwordx4 v7, s[8:11], s84 offen offset:0 lds
    s_mul_i32 s86, s78, 1792
    s_add_u32 s79, s78, 128
    s_and_b32 s79, s79, 1023
    s_mul_i32 s87, s79, 1792
    s_add_u32 s80, s79, 128
    s_and_b32 s80, s80, 1023
    s_mul_i32 s88, s80, 1792
    s_add_u32 s81, s80, 128
    s_and_b32 s81, s81, 1023
    s_mul_i32 s89, s81, 1792
    s_add_u32 s82, s81, 128
    s_and_b32 s82, s82, 1023
    s_mul_i32 s90, s82, 1792
    s_add_u32 s83, s82, 128
    s_and_b32 s83, s83, 1023
    s_mul_i32 s91, s83, 1792
    buffer_load_dwordx4 v8, s[8:11], s84 offen offset:1024 lds
    v_and_b32 v68, 31, v1
    v_lshrrev_b32 v69, 5, v1
    v_lshrrev_b32 v70, 1, v68
    v_and_b32 v70, 7, v70
    v_xor_b32 v70, v70, v69
    v_lshlrev_b32 v70, 4, v70
    v_lshl_add_u32 v70, v68, 7, v70
    s_and_b32 s30, s60, 1
    s_lshl_b32 s30, s30, 13
    v_add_u32 v11, s30, v70
    v_xor_b32 v12, 32, v11
    v_xor_b32 v13, 64, v11
    v_xor_b32 v14, 96, v11
    v_add_u32 v15, 68608, v11
    v_add_u32 v16, 68608, v12
    v_add_u32 v17, 68608, v13
    buffer_load_dwordx4 v9, s[8:11], s84 offen offset:2048 lds
    v_add_u32 v18, 68608, v14
    v_bfe_u32 v70, v1, 2, 2
    v_bfe_u32 v71, v1, 4, 1
    v_bfe_u32 v68, v1, 1, 1
    v_lshl_add_u32 v71, v71, 1, v68
    s_lshr_b32 s30, s60, 1
    s_lshl_b32 s30, s30, 3
    v_or_b32 v71, s30, v71
    v_lshlrev_b32 v68, 2, v70
    v_xor_b32 v71, v71, v68
    v_lshlrev_b32 v71, 4, v71
    v_lshl_add_u32 v70, v69, 3, v70
    v_lshl_add_u32 v71, v70, 8, v71
    v_and_b32 v68, 1, v1
    v_lshl_add_u32 v71, v68, 3, v71
    v_add_u32 v19, 16384, v71
    v_xor_b32 v20, 64, v19
    buffer_load_dwordx4 v10, s[8:11], s84 offen offset:3072 lds
    v_add_u32 v21, 68608, v19
    v_add_u32 v22, 68608, v20
    s_lshr_b32 s98, s60, 1
    s_and_b32 s99, s60, 1
    s_mul_i32 s96, s98, 31232
    s_add_u32 s96, s96, 101376
    v_and_b32 v73, 127, v0
    v_lshrrev_b32 v74, 2, v73
    v_mul_u32_u24 v74, 976, v74
    v_and_b32 v73, 3, v73
    v_lshl_add_u32 v73, v73, 2, v74
    v_add_u32 v73, s96, v73
    v_and_b32 v76, 31, v1
    v_lshrrev_b32 v77, 5, v1
    v_mul_u32_u24 v74, 976, v77
    v_add_u32 v74, s96, v74
    s_add_u32 m0, s92, 16384
    s_nop 0
    buffer_load_dwordx4 v7, s[8:11], s85 offen offset:0 lds
    v_add_u32 v75, 32, v76
    v_lshlrev_b32 v78, 2, v76
    v_subrev_u32 v78, 101, v78
    v_cmp_lt_u32 vcc, 27, v76
    s_nop 1
    v_cndmask_b32 v75, v75, v78, vcc
    v_lshl_add_u32 v227, v75, 4, v74
    v_lshl_add_u32 v226, v76, 4, v74
    s_mul_i32 s30, s60, 4224
    s_add_u32 s30, s30, 131072
    v_sub_u32 v224, s30, v2
    v_lshlrev_b32 v79, 9, v77
    v_sub_u32 v225, v224, v79
    v_or_b32 v229, s99, v1
    s_sub_u32 s66, 0, s99
    s_mov_b32 s67, s66
    s_or_b32 s68, s66, 0xaaaaaaaa
    buffer_load_dwordx4 v8, s[8:11], s85 offen offset:1024 lds
    s_mov_b32 s69, s68
    s_and_b32 s70, s66, 0xaaaaaaaa
    s_mov_b32 s71, s70
    v_mov_b32 v240, 0
    v_mov_b32 v241, 0
    v_mov_b32 v242, 0
    v_mov_b32 v243, 0
    s_lshl_b32 s28, s2, 2
    s_add_u32 s28, s28, s60
    s_and_b32 s29, s28, 0xffe0
    s_add_u32 s28, s28, s29
    s_lshl_b32 s28, s28, 10
    v_and_b32 v41, 7, v1
    v_lshl_add_u32 v41, v41, 7, s28
    v_bfe_u32 v68, v1, 3, 1
    v_lshl_add_u32 v41, v68, 15, v41
    buffer_load_dwordx4 v9, s[8:11], s85 offen offset:2048 lds
    v_and_b32 v244, 31, v1
    v_lshrrev_b32 v245, 5, v1
    v_and_b32 v246, 15, v1
    v_lshrrev_b32 v247, 4, v1
    v_bfe_u32 v248, v1, 4, 1
    v_bfe_u32 v249, v1, 2, 2
    v_and_b32 v250, 3, v1
    v_lshrrev_b32 v251, 3, v1
    v_lshlrev_b32 v252, 2, v248
    v_and_b32 v253, 7, v1
    v_xor_b32 v252, v252, v253
    v_lshlrev_b32 v252, 4, v252
    v_lshl_add_u32 v253, v251, 10, v252
    s_mul_i32 s28, s60, 458752
    s_lshl_b32 s29, s65, 7
    s_add_u32 s28, s28, s29
    v_add_u32 v36, s28, v253
    v_add_u32 v37, 7168, v36
    v_add_u32 v28, 14336, v36
    v_add_u32 v42, 21504, v36
    s_mov_b32 s33, 65536
    v_lshl_add_u32 v253, v251, 12, v252
    s_lshl_b32 s28, s65, 2
    s_add_u32 s28, s28, s60
    s_lshl_b32 s28, s28, 16
    s_lshl_b32 s29, s64, 7
    s_add_u32 s28, s28, s29
    s_add_u32 s28, s28, 2162688
    v_add_u32 v48, s28, v253
    v_add_u32 v49, 31744, v48
    s_lshl_b32 s28, s60, 11
    s_add_u32 s95, s28, 143360
    v_lshl_add_u32 v251, v245, 2, v249
    v_lshlrev_b32 v251, 7, v251
    v_bfe_u32 v252, v1, 1, 1
    v_lshl_add_u32 v252, v248, 1, v252
    v_bfe_u32 v253, v1, 3, 1
    v_lshl_add_u32 v252, v253, 2, v252
    v_lshl_add_u32 v252, v252, 4, v251
    v_and_b32 v254, 1, v1
    v_lshl_add_u32 v252, v254, 3, v252
    s_lshl_b32 s28, s98, 6
    v_xor_b32 v252, s28, v252
    s_add_u32 s28, s92, 35840
    v_add_u32 v38, s28, v252
    v_xor_b32 v39, 64, v38
    v_lshl_add_u32 v251, v250, 4, v251
    v_lshl_add_u32 v251, v248, 3, v251
    v_xor_b32 v253, s99, v253
    v_lshl_add_u32 v251, v253, 6, v251
    s_lshl_b32 s29, s98, 12
    s_add_u32 s29, s29, 143360
    v_add_u32 v56, s29, v251
    s_or_b32 s30, s2, s60
    s_cmp_lg_u32 s30, 0
    s_cbranch_scc1 L_nopub
    s_waitcnt lgkmcnt(0)
    s_mul_i32 s30, s63, 1664525
    s_add_u32 s30, s30, 1013904223
    v_mov_b32 v30, s30
    v_mov_b32 v31, 1
    s_mov_b64 exec, 1
    buffer_store_dwordx2 v[30:31], v26, s[24:27], 0 offen sc1
    s_mov_b64 exec, -1
L_nopub:
    s_waitcnt lgkmcnt(0)
    s_lshl_b32 s31, s72, 16
    s_and_b32 s3, s72, 0xffff0000
    s_cmp_eq_u32 s98, 0
    s_cselect_b32 s72, s31, s3
    s_lshl_b32 s31, s73, 16
    s_and_b32 s3, s73, 0xffff0000
    s_cmp_eq_u32 s98, 0
    s_cselect_b32 s73, s31, s3
    s_mov_b32 s31, 0x3fb8aa3b
    s_mov_b32 s3, 0x32a57060
    v_mov_b32 v68, s72
    v_mul_f32 v69, s31, v68
    v_fma_f32 v70, v68, s31, -v69
    v_fmac_f32 v70, s3, v68
    v_exp_f32 v69, v69
    v_mul_f32 v70, 0x3f317218, v70
    v_fma_f32 v68, v69, v70, v69
    v_mov_b32 v228, s73
    v_cmp_eq_u32 vcc, 0, v1
    s_nop 1
    v_cndmask_b32 v228, 0, v228, vcc
    buffer_load_dwordx4 v10, s[8:11], s85 offen offset:3072 lds
    s_waitcnt vmcnt(12)
    v_mul_f32 v69, s31, v64
    v_fma_f32 v70, v64, s31, -v69
    v_fmac_f32 v70, s3, v64
    v_exp_f32 v69, v69
    v_mul_f32 v70, 0x3f317218, v70
    v_fma_f32 v69, v69, v70, v69
    v_cvt_pk_bf16_f32 v68, v68, v69
    v_and_b32 v69, 0xffff0000, v68
    v_lshlrev_b32 v68, 16, v68
    v_mul_f32 v69, v69, v68
    v_mul_f32 v65, v65, v68
    v_mul_f32 v69, s31, v69
    v_mul_f32 v65, 0.15915494, v65
    v_add_f32 v68, v68, v68
    v_pk_mul_f32 v[66:67], v[66:67], v[68:69] op_sel_hi:[1,0]
    v_mul_f32 v96, 0xc1000000, v69
    v_mul_f32 v97, 0x41000000, v65
    v_exp_f32 v96, v96
    v_fract_f32 v97, v97
    v_cos_f32 v82, v97
    v_sin_f32 v83, v97
    v_mul_f32 v98, 0xbf800000, v69
    v_mul_f32 v99, 0x3f800000, v65
    v_exp_f32 v98, v98
    v_fract_f32 v99, v99
    v_cos_f32 v80, v99
    v_sin_f32 v81, v99
    v_mul_f32 v100, 0xc3800000, v69
    v_mul_f32 v101, 0x43800000, v65
    v_exp_f32 v100, v100
    v_fract_f32 v101, v101
    v_cos_f32 v84, v101
    v_sin_f32 v85, v101
    v_pk_mul_f32 v[82:83], v[82:83], v[96:97] op_sel_hi:[1,0]
    v_pk_mul_f32 v[80:81], v[80:81], v[98:99] op_sel_hi:[1,0]
    v_pk_mul_f32 v[84:85], v[84:85], v[100:101] op_sel_hi:[1,0]
    v_mov_b32 v120, 0x3f80
    v_pk_mul_f32 v[122:123], v[82:83], v[82:83] op_sel:[0,0] op_sel_hi:[1,0]
    v_cvt_pk_bf16_f32 v104, v66, -v67
    v_pk_mul_f32 v[86:87], v[80:81], v[80:81] op_sel:[0,0] op_sel_hi:[1,0]
    v_pk_fma_f32 v[122:123], v[82:83], v[82:83], v[122:123] op_sel:[1,1,0] op_sel_hi:[0,1,1] neg_lo:[0,1,0]
    v_cvt_pk_bf16_f32 v105, v82, v83
    ds_write2_b32 v73, v120, v104 offset0:128 offset1:0
    v_pk_fma_f32 v[86:87], v[80:81], v[80:81], v[86:87] op_sel:[1,1,0] op_sel_hi:[0,1,1] neg_lo:[0,1,0]
    v_pk_mul_f32 v[124:125], v[122:123], v[82:83] op_sel:[0,0] op_sel_hi:[1,0]
    v_pk_mul_f32 v[90:91], v[66:67], v[80:81] op_sel:[0,0] op_sel_hi:[1,0]
    v_pk_fma_f32 v[124:125], v[122:123], v[82:83], v[124:125] op_sel:[1,1,0] op_sel_hi:[0,1,1] neg_lo:[0,1,0]
    v_cvt_pk_bf16_f32 v106, v122, v123
    v_pk_fma_f32 v[90:91], v[66:67], v[80:81], v[90:91] op_sel:[1,1,0] op_sel_hi:[0,1,1] neg_lo:[0,1,0]
    v_pk_mul_f32 v[122:123], v[124:125], v[82:83] op_sel:[0,0] op_sel_hi:[1,0]
    v_cvt_pk_bf16_f32 v107, v90, -v91
    ds_write2_b32 v73, v105, v106 offset0:132 offset1:136
    v_pk_mul_f32 v[92:93], v[90:91], v[80:81] op_sel:[0,0] op_sel_hi:[1,0]
    v_pk_fma_f32 v[122:123], v[124:125], v[82:83], v[122:123] op_sel:[1,1,0] op_sel_hi:[0,1,1] neg_lo:[0,1,0]
    v_cvt_pk_bf16_f32 v108, v124, v125
    v_pk_fma_f32 v[92:93], v[90:91], v[80:81], v[92:93] op_sel:[1,1,0] op_sel_hi:[0,1,1] neg_lo:[0,1,0]
    v_pk_mul_f32 v[124:125], v[122:123], v[82:83] op_sel:[0,0] op_sel_hi:[1,0]
    v_cvt_pk_bf16_f32 v109, v92, -v93
    ds_write2_b32 v73, v107, v108 offset0:4 offset1:140
    v_pk_mul_f32 v[90:91], v[92:93], v[80:81] op_sel:[0,0] op_sel_hi:[1,0]
    v_pk_fma_f32 v[124:125], v[122:123], v[82:83], v[124:125] op_sel:[1,1,0] op_sel_hi:[0,1,1] neg_lo:[0,1,0]
    v_cvt_pk_bf16_f32 v110, v122, v123
    v_pk_fma_f32 v[90:91], v[92:93], v[80:81], v[90:91] op_sel:[1,1,0] op_sel_hi:[0,1,1] neg_lo:[0,1,0]
    v_pk_mul_f32 v[122:123], v[124:125], v[82:83] op_sel:[0,0] op_sel_hi:[1,0]
    v_cvt_pk_bf16_f32 v111, v90, -v91
    ds_write2_b32 v73, v109, v110 offset0:8 offset1:144
    v_pk_mul_f32 v[92:93], v[90:91], v[80:81] op_sel:[0,0] op_sel_hi:[1,0]
    v_pk_fma_f32 v[122:123], v[124:125], v[82:83], v[122:123] op_sel:[1,1,0] op_sel_hi:[0,1,1] neg_lo:[0,1,0]
    v_cvt_pk_bf16_f32 v112, v124, v125
    v_pk_fma_f32 v[92:93], v[90:91], v[80:81], v[92:93] op_sel:[1,1,0] op_sel_hi:[0,1,1] neg_lo:[0,1,0]
    v_pk_mul_f32 v[124:125], v[122:123], v[82:83] op_sel:[0,0] op_sel_hi:[1,0]
    v_cvt_pk_bf16_f32 v113, v92, -v93
    ds_write2_b32 v73, v111, v112 offset0:12 offset1:148
    v_pk_mul_f32 v[90:91], v[92:93], v[80:81] op_sel:[0,0] op_sel_hi:[1,0]
    v_pk_fma_f32 v[124:125], v[122:123], v[82:83], v[124:125] op_sel:[1,1,0] op_sel_hi:[0,1,1] neg_lo:[0,1,0]
    v_cvt_pk_bf16_f32 v114, v122, v123
    v_pk_fma_f32 v[90:91], v[92:93], v[80:81], v[90:91] op_sel:[1,1,0] op_sel_hi:[0,1,1] neg_lo:[0,1,0]
    v_pk_mul_f32 v[122:123], v[124:125], v[82:83] op_sel:[0,0] op_sel_hi:[1,0]
    v_cvt_pk_bf16_f32 v115, v90, -v91
    ds_write2_b32 v73, v113, v114 offset0:16 offset1:152
    v_pk_mul_f32 v[92:93], v[90:91], v[80:81] op_sel:[0,0] op_sel_hi:[1,0]
    v_pk_fma_f32 v[122:123], v[124:125], v[82:83], v[122:123] op_sel:[1,1,0] op_sel_hi:[0,1,1] neg_lo:[0,1,0]
    v_cvt_pk_bf16_f32 v116, v124, v125
    v_pk_fma_f32 v[92:93], v[90:91], v[80:81], v[92:93] op_sel:[1,1,0] op_sel_hi:[0,1,1] neg_lo:[0,1,0]
    v_pk_mul_f32 v[124:125], v[122:123], v[82:83] op_sel:[0,0] op_sel_hi:[1,0]
    v_cvt_pk_bf16_f32 v117, v92, -v93
    ds_write2_b32 v73, v115, v116 offset0:20 offset1:156
    v_pk_mul_f32 v[90:91], v[92:93], v[80:81] op_sel:[0,0] op_sel_hi:[1,0]
    v_pk_fma_f32 v[124:125], v[122:123], v[82:83], v[124:125] op_sel:[1,1,0] op_sel_hi:[0,1,1] neg_lo:[0,1,0]
    v_cvt_pk_bf16_f32 v118, v122, v123
    v_pk_fma_f32 v[90:91], v[92:93], v[80:81], v[90:91] op_sel:[1,1,0] op_sel_hi:[0,1,1] neg_lo:[0,1,0]
    v_pk_mul_f32 v[122:123], v[124:125], v[82:83] op_sel:[0,0] op_sel_hi:[1,0]
    v_cvt_pk_bf16_f32 v119, v90, -v91
    ds_write2_b32 v73, v117, v118 offset0:24 offset1:160
    v_pk_mul_f32 v[88:89], v[86:87], v[86:87] op_sel:[0,0] op_sel_hi:[1,0]
    v_pk_fma_f32 v[122:123], v[124:125], v[82:83], v[122:123] op_sel:[1,1,0] op_sel_hi:[0,1,1] neg_lo:[0,1,0]
    v_cvt_pk_bf16_f32 v104, v124, v125
    v_pk_fma_f32 v[88:89], v[86:87], v[86:87], v[88:89] op_sel:[1,1,0] op_sel_hi:[0,1,1] neg_lo:[0,1,0]
    v_pk_mul_f32 v[124:125], v[122:123], v[82:83] op_sel:[0,0] op_sel_hi:[1,0]
    v_pk_mul_f32 v[94:95], v[66:67], v[84:85] op_sel:[0,0] op_sel_hi:[1,0]
    v_pk_fma_f32 v[124:125], v[122:123], v[82:83], v[124:125] op_sel:[1,1,0] op_sel_hi:[0,1,1] neg_lo:[0,1,0]
    v_cvt_pk_bf16_f32 v105, v122, v123
    ds_write2_b32 v73, v119, v104 offset0:28 offset1:164
    v_pk_fma_f32 v[94:95], v[66:67], v[84:85], v[94:95] op_sel:[1,1,0] op_sel_hi:[0,1,1] neg_lo:[0,1,0]
    v_pk_mul_f32 v[122:123], v[124:125], v[82:83] op_sel:[0,0] op_sel_hi:[1,0]
    v_cvt_pk_bf16_f32 v106, v94, -v95
    v_pk_mul_f32 v[90:91], v[94:95], v[86:87] op_sel:[0,0] op_sel_hi:[1,0]
    v_pk_fma_f32 v[122:123], v[124:125], v[82:83], v[122:123] op_sel:[1,1,0] op_sel_hi:[0,1,1] neg_lo:[0,1,0]
    v_cvt_pk_bf16_f32 v107, v124, v125
    ds_write2_b32 v73, v105, v106 offset0:168 offset1:32
    v_pk_fma_f32 v[90:91], v[94:95], v[86:87], v[90:91] op_sel:[1,1,0] op_sel_hi:[0,1,1] neg_lo:[0,1,0]
    v_pk_mul_f32 v[124:125], v[122:123], v[82:83] op_sel:[0,0] op_sel_hi:[1,0]
    v_cvt_pk_bf16_f32 v108, v90, -v91
    v_pk_mul_f32 v[92:93], v[90:91], v[86:87] op_sel:[0,0] op_sel_hi:[1,0]
    v_pk_fma_f32 v[124:125], v[122:123], v[82:83], v[124:125] op_sel:[1,1,0] op_sel_hi:[0,1,1] neg_lo:[0,1,0]
    v_cvt_pk_bf16_f32 v109, v122, v123
    ds_write2_b32 v73, v107, v108 offset0:172 offset1:36
    v_pk_fma_f32 v[92:93], v[90:91], v[86:87], v[92:93] op_sel:[1,1,0] op_sel_hi:[0,1,1] neg_lo:[0,1,0]
    v_pk_mul_f32 v[122:123], v[124:125], v[82:83] op_sel:[0,0] op_sel_hi:[1,0]
    v_cvt_pk_bf16_f32 v110, v92, -v93
    ds_write2_b32 v73, v109, v110 offset0:176 offset1:40
    v_pk_mul_f32 v[90:91], v[92:93], v[86:87] op_sel:[0,0] op_sel_hi:[1,0]
    v_pk_fma_f32 v[122:123], v[124:125], v[82:83], v[122:123] op_sel:[1,1,0] op_sel_hi:[0,1,1] neg_lo:[0,1,0]
    v_cvt_pk_bf16_f32 v111, v124, v125
    v_pk_fma_f32 v[90:91], v[92:93], v[86:87], v[90:91] op_sel:[1,1,0] op_sel_hi:[0,1,1] neg_lo:[0,1,0]
    v_pk_mul_f32 v[124:125], v[122:123], v[82:83] op_sel:[0,0] op_sel_hi:[1,0]
    v_cvt_pk_bf16_f32 v112, v90, -v91
    ds_write2_b32 v73, v110, v111 offset0:48 offset1:180
    v_pk_mul_f32 v[92:93], v[90:91], v[86:87] op_sel:[0,0] op_sel_hi:[1,0]
    v_pk_fma_f32 v[124:125], v[122:123], v[82:83], v[124:125] op_sel:[1,1,0] op_sel_hi:[0,1,1] neg_lo:[0,1,0]
    s_add_u32 m0, s92, 0
    s_nop 0
    buffer_load_dwordx4 v3, s[4:7], s77 offen offset:0 lds
    v_cvt_pk_bf16_f32 v113, v122, v123
    v_pk_fma_f32 v[92:93], v[90:91], v[86:87], v[92:93] op_sel:[1,1,0] op_sel_hi:[0,1,1] neg_lo:[0,1,0]
    v_pk_mul_f32 v[122:123], v[124:125], v[82:83] op_sel:[0,0] op_sel_hi:[1,0]
    v_cvt_pk_bf16_f32 v114, v92, -v93
    ds_write2_b32 v73, v112, v113 offset0:52 offset1:184
    v_pk_mul_f32 v[66:67], v[94:95], v[84:85] op_sel:[0,0] op_sel_hi:[1,0]
    v_pk_fma_f32 v[122:123], v[124:125], v[82:83], v[122:123] op_sel:[1,1,0] op_sel_hi:[0,1,1] neg_lo:[0,1,0]
    v_cvt_pk_bf16_f32 v115, v124, v125
    v_pk_fma_f32 v[66:67], v[94:95], v[84:85], v[66:67] op_sel:[1,1,0] op_sel_hi:[0,1,1] neg_lo:[0,1,0]
    v_pk_mul_f32 v[124:125], v[122:123], v[82:83] op_sel:[0,0] op_sel_hi:[1,0]
    v_cvt_pk_bf16_f32 v116, v66, -v67
    ds_write2_b32 v73, v114, v115 offset0:56 offset1:188
    v_pk_mul_f32 v[90:91], v[66:67], v[88:89] op_sel:[0,0] op_sel_hi:[1,0]
    v_pk_fma_f32 v[124:125], v[122:123], v[82:83], v[124:125] op_sel:[1,1,0] op_sel_hi:[0,1,1] neg_lo:[0,1,0]
    v_cvt_pk_bf16_f32 v117, v122, v123
    v_pk_fma_f32 v[90:91], v[66:67], v[88:89], v[90:91] op_sel:[1,1,0] op_sel_hi:[0,1,1] neg_lo:[0,1,0]
    v_pk_mul_f32 v[122:123], v[124:125], v[82:83] op_sel:[0,0] op_sel_hi:[1,0]
    v_cvt_pk_bf16_f32 v118, v90, -v91
    ds_write2_b32 v73, v116, v117 offset0:64 offset1:192
    v_pk_mul_f32 v[92:93], v[66:67], v[82:83] op_sel:[0,0] op_sel_hi:[1,0]
    v_pk_fma_f32 v[122:123], v[124:125], v[82:83], v[122:123] op_sel:[1,1,0] op_sel_hi:[0,1,1] neg_lo:[0,1,0]
    v_cvt_pk_bf16_f32 v119, v124, v125
    v_pk_fma_f32 v[92:93], v[66:67], v[82:83], v[92:93] op_sel:[1,1,0] op_sel_hi:[0,1,1] neg_lo:[0,1,0]
    v_pk_mul_f32 v[124:125], v[122:123], v[82:83] op_sel:[0,0] op_sel_hi:[1,0]
    v_cvt_pk_bf16_f32 v104, v92, -v93
    buffer_load_dwordx4 v4, s[4:7], s77 offen offset:1024 lds
    ds_write2_b32 v73, v118, v119 offset0:68 offset1:196
    v_pk_mul_f32 v[94:95], v[66:67], v[84:85] op_sel:[0,0] op_sel_hi:[1,0]
    v_pk_fma_f32 v[124:125], v[122:123], v[82:83], v[124:125] op_sel:[1,1,0] op_sel_hi:[0,1,1] neg_lo:[0,1,0]
    v_cvt_pk_bf16_f32 v105, v122, v123
    v_pk_fma_f32 v[94:95], v[66:67], v[84:85], v[94:95] op_sel:[1,1,0] op_sel_hi:[0,1,1] neg_lo:[0,1,0]
    v_pk_mul_f32 v[122:123], v[124:125], v[82:83] op_sel:[0,0] op_sel_hi:[1,0]
    v_cvt_pk_bf16_f32 v106, v94, -v95
    ds_write2_b32 v73, v104, v105 offset0:72 offset1:200
    v_pk_mul_f32 v[90:91], v[94:95], v[88:89] op_sel:[0,0] op_sel_hi:[1,0]
    v_pk_fma_f32 v[122:123], v[124:125], v[82:83], v[122:123] op_sel:[1,1,0] op_sel_hi:[0,1,1] neg_lo:[0,1,0]
    v_cvt_pk_bf16_f32 v107, v124, v125
    v_pk_fma_f32 v[90:91], v[94:95], v[88:89], v[90:91] op_sel:[1,1,0] op_sel_hi:[0,1,1] neg_lo:[0,1,0]
    v_pk_mul_f32 v[124:125], v[122:123], v[82:83] op_sel:[0,0] op_sel_hi:[1,0]
    v_cvt_pk_bf16_f32 v108, v90, -v91
    ds_write2_b32 v73, v106, v107 offset0:80 offset1:204
    v_pk_mul_f32 v[92:93], v[94:95], v[82:83] op_sel:[0,0] op_sel_hi:[1,0]
    v_pk_fma_f32 v[124:125], v[122:123], v[82:83], v[124:125] op_sel:[1,1,0] op_sel_hi:[0,1,1] neg_lo:[0,1,0]
    v_cvt_pk_bf16_f32 v109, v122, v123
    v_pk_fma_f32 v[92:93], v[94:95], v[82:83], v[92:93] op_sel:[1,1,0] op_sel_hi:[0,1,1] neg_lo:[0,1,0]
    v_pk_mul_f32 v[122:123], v[124:125], v[82:83] op_sel:[0,0] op_sel_hi:[1,0]
    v_cvt_pk_bf16_f32 v110, v92, -v93
    ds_write2_b32 v73, v108, v109 offset0:84 offset1:208
    v_pk_mul_f32 v[66:67], v[94:95], v[84:85] op_sel:[0,0] op_sel_hi:[1,0]
    v_pk_fma_f32 v[122:123], v[124:125], v[82:83], v[122:123] op_sel:[1,1,0] op_sel_hi:[0,1,1] neg_lo:[0,1,0]
    v_cvt_pk_bf16_f32 v111, v124, v125
    buffer_load_dwordx4 v5, s[4:7], s77 offen offset:2048 lds
    v_pk_fma_f32 v[66:67], v[94:95], v[84:85], v[66:67] op_sel:[1,1,0] op_sel_hi:[0,1,1] neg_lo:[0,1,0]
    v_pk_mul_f32 v[124:125], v[122:123], v[82:83] op_sel:[0,0] op_sel_hi:[1,0]
    v_cvt_pk_bf16_f32 v112, v66, -v67
    ds_write2_b32 v73, v110, v111 offset0:88 offset1:212
    v_pk_mul_f32 v[90:91], v[66:67], v[82:83] op_sel:[0,0] op_sel_hi:[1,0]
    v_pk_fma_f32 v[124:125], v[122:123], v[82:83], v[124:125] op_sel:[1,1,0] op_sel_hi:[0,1,1] neg_lo:[0,1,0]
    v_cvt_pk_bf16_f32 v113, v122, v123
    v_pk_fma_f32 v[90:91], v[66:67], v[82:83], v[90:91] op_sel:[1,1,0] op_sel_hi:[0,1,1] neg_lo:[0,1,0]
    v_pk_mul_f32 v[122:123], v[124:125], v[82:83] op_sel:[0,0] op_sel_hi:[1,0]
    v_cvt_pk_bf16_f32 v114, v90, -v91
    ds_write2_b32 v73, v112, v113 offset0:96 offset1:216
    v_pk_mul_f32 v[94:95], v[66:67], v[84:85] op_sel:[0,0] op_sel_hi:[1,0]
    v_pk_fma_f32 v[122:123], v[124:125], v[82:83], v[122:123] op_sel:[1,1,0] op_sel_hi:[0,1,1] neg_lo:[0,1,0]
    v_cvt_pk_bf16_f32 v115, v124, v125
    v_pk_fma_f32 v[94:95], v[66:67], v[84:85], v[94:95] op_sel:[1,1,0] op_sel_hi:[0,1,1] neg_lo:[0,1,0]
    v_pk_mul_f32 v[124:125], v[122:123], v[82:83] op_sel:[0,0] op_sel_hi:[1,0]
    v_cvt_pk_bf16_f32 v116, v94, -v95
    ds_write2_b32 v73, v114, v115 offset0:100 offset1:220
    v_pk_mul_f32 v[90:91], v[94:95], v[82:83] op_sel:[0,0] op_sel_hi:[1,0]
    v_pk_fma_f32 v[124:125], v[122:123], v[82:83], v[124:125] op_sel:[1,1,0] op_sel_hi:[0,1,1] neg_lo:[0,1,0]
    v_cvt_pk_bf16_f32 v117, v122, v123
    v_pk_fma_f32 v[90:91], v[94:95], v[82:83], v[90:91] op_sel:[1,1,0] op_sel_hi:[0,1,1] neg_lo:[0,1,0]
    v_pk_mul_f32 v[122:123], v[124:125], v[82:83] op_sel:[0,0] op_sel_hi:[1,0]
    v_cvt_pk_bf16_f32 v118, v90, -v91
    ds_write2_b32 v73, v116, v117 offset0:104 offset1:224
    buffer_load_dwordx4 v6, s[4:7], s77 offen offset:3072 lds
    v_pk_mul_f32 v[66:67], v[94:95], v[84:85] op_sel:[0,0] op_sel_hi:[1,0]
    v_pk_fma_f32 v[122:123], v[124:125], v[82:83], v[122:123] op_sel:[1,1,0] op_sel_hi:[0,1,1] neg_lo:[0,1,0]
    v_cvt_pk_bf16_f32 v119, v124, v125
    v_pk_fma_f32 v[66:67], v[94:95], v[84:85], v[66:67] op_sel:[1,1,0] op_sel_hi:[0,1,1] neg_lo:[0,1,0]
    v_pk_mul_f32 v[124:125], v[122:123], v[82:83] op_sel:[0,0] op_sel_hi:[1,0]
    v_cvt_pk_bf16_f32 v104, v66, -v67
    ds_write2_b32 v73, v118, v119 offset0:108 offset1:228
    v_pk_mul_f32 v[90:91], v[66:67], v[82:83] op_sel:[0,0] op_sel_hi:[1,0]
    v_pk_fma_f32 v[124:125], v[122:123], v[82:83], v[124:125] op_sel:[1,1,0] op_sel_hi:[0,1,1] neg_lo:[0,1,0]
    v_cvt_pk_bf16_f32 v105, v122, v123
    v_pk_fma_f32 v[90:91], v[66:67], v[82:83], v[90:91] op_sel:[1,1,0] op_sel_hi:[0,1,1] neg_lo:[0,1,0]
    v_pk_mul_f32 v[122:123], v[124:125], v[82:83] op_sel:[0,0] op_sel_hi:[1,0]
    v_cvt_pk_bf16_f32 v106, v90, -v91
    ds_write2_b32 v73, v104, v105 offset0:112 offset1:232
    v_pk_mul_f32 v[94:95], v[66:67], v[84:85] op_sel:[0,0] op_sel_hi:[1,0]
    v_pk_fma_f32 v[122:123], v[124:125], v[82:83], v[122:123] op_sel:[1,1,0] op_sel_hi:[0,1,1] neg_lo:[0,1,0]
    v_cvt_pk_bf16_f32 v107, v124, v125
    v_pk_fma_f32 v[94:95], v[66:67], v[84:85], v[94:95] op_sel:[1,1,0] op_sel_hi:[0,1,1] neg_lo:[0,1,0]
    v_pk_mul_f32 v[124:125], v[122:123], v[82:83] op_sel:[0,0] op_sel_hi:[1,0]
    v_cvt_pk_bf16_f32 v108, v94, -v95
    ds_write2_b32 v73, v106, v107 offset0:116 offset1:236
    v_pk_mul_f32 v[90:91], v[94:95], v[82:83] op_sel:[0,0] op_sel_hi:[1,0]
    v_pk_fma_f32 v[124:125], v[122:123], v[82:83], v[124:125] op_sel:[1,1,0] op_sel_hi:[0,1,1] neg_lo:[0,1,0]
    v_cvt_pk_bf16_f32 v109, v122, v123
    v_pk_fma_f32 v[90:91], v[94:95], v[82:83], v[90:91] op_sel:[1,1,0] op_sel_hi:[0,1,1] neg_lo:[0,1,0]
    buffer_load_dword v63, v41, s[12:15], 0 offen
    v_pk_mul_f32 v[122:123], v[124:125], v[82:83] op_sel:[0,0] op_sel_hi:[1,0]
    v_cvt_pk_bf16_f32 v110, v90, -v91
    ds_write2_b32 v73, v108, v109 offset0:120 offset1:44
    v_pk_fma_f32 v[122:123], v[124:125], v[82:83], v[122:123] op_sel:[1,1,0] op_sel_hi:[0,1,1] neg_lo:[0,1,0]
    v_cvt_pk_bf16_f32 v111, v124, v125
    v_pk_mul_f32 v[124:125], v[122:123], v[82:83] op_sel:[0,0] op_sel_hi:[1,0]
    v_pk_fma_f32 v[124:125], v[122:123], v[82:83], v[124:125] op_sel:[1,1,0] op_sel_hi:[0,1,1] neg_lo:[0,1,0]
    v_cvt_pk_bf16_f32 v112, v122, v123
    ds_write2_b32 v73, v110, v111 offset0:124 offset1:60
    v_cvt_pk_bf16_f32 v113, v124, v125
    ds_write2_b32 v73, v112, v113 offset0:76 offset1:92
    s_waitcnt vmcnt(9) lgkmcnt(0)
    s_barrier
    ds_read_b64_tr_b16 v[64:65], v19 offset:35840
    ds_read_b64_tr_b16 v[66:67], v19 offset:36864
    ds_read_b128 v[72:75], v11 offset:35840
    ds_read_b128 v[76:79], v11 offset:39936
    ds_read_b64_tr_b16 v[68:69], v20 offset:35840
    ds_read_b64_tr_b16 v[70:71], v20 offset:36864
    ds_read_b128 a[96:99], v226 offset:0
    ds_read_b128 a[100:103], v227 offset:0
    ds_read_b128 a[104:107], v226 offset:1952
    ds_read_b128 a[108:111], v227 offset:1952
    ds_read_b128 a[112:115], v226 offset:3904
    ds_read_b128 a[116:119], v227 offset:3904
    s_waitcnt lgkmcnt(6)
    v_mfma_f32_32x32x16_bf16 v[128:143], v[64:67], v[72:75], 0
    ds_read_b64_tr_b16 v[80:81], v19 offset:39936
    ds_read_b64_tr_b16 v[82:83], v19 offset:40960
    s_add_u32 m0, s92, 84992
    s_nop 0
    buffer_load_dwordx4 v7, s[8:11], s86 offen offset:0 lds
    v_mfma_f32_32x32x16_bf16 v[144:159], v[64:67], v[76:79], 0
    ds_read_b128 v[88:91], v12 offset:35840
    ds_read_b128 v[92:95], v12 offset:39936
    buffer_load_dwordx4 v8, s[8:11], s86 offen offset:1024 lds
    s_waitcnt lgkmcnt(8)
    v_mfma_f32_32x32x16_bf16 v[192:207], a[96:99], a[100:103], 0
    ds_read_b128 a[120:123], v226 offset:5856
    ds_read_b128 a[124:127], v227 offset:5856
    v_mfma_f32_32x32x16_bf16 v[160:175], v[68:71], v[72:75], 0
    ds_read_b64_tr_b16 v[84:85], v20 offset:39936
    ds_read_b64_tr_b16 v[86:87], v20 offset:40960
    s_waitcnt lgkmcnt(10)
    v_mfma_f32_32x32x16_bf16 v[192:207], a[104:107], a[108:111], v[192:207]
    ds_read_b128 a[128:131], v226 offset:7808
    ds_read_b128 a[132:135], v227 offset:7808
    v_mfma_f32_32x32x16_bf16 v[176:191], v[68:71], v[76:79], 0
    buffer_load_dwordx4 v9, s[8:11], s86 offen offset:2048 lds
    v_lshrrev_b32 v251, 1, v246
    v_sub_u32 v251, v247, v251
    s_waitcnt lgkmcnt(10)
    v_mfma_f32_32x32x16_bf16 v[192:207], a[112:115], a[116:119], v[192:207]
    ds_read_b128 a[136:139], v226 offset:9760
    ds_read_b128 a[140:143], v227 offset:9760
    s_waitcnt lgkmcnt(6)
    v_mfma_f32_32x32x16_bf16 v[192:207], a[120:123], a[124:127], v[192:207]
    ds_read_b128 a[144:147], v226 offset:11712
    ds_read_b128 a[148:151], v227 offset:11712
    s_waitcnt lgkmcnt(6)
    v_mfma_f32_32x32x16_bf16 v[128:143], v[80:83], v[88:91], v[128:143]
    ds_read_b64_tr_b16 v[64:65], v19 offset:44032
    ds_read_b64_tr_b16 v[66:67], v19 offset:45056
    v_lshlrev_b32 v251, 4, v251
    v_mul_u32_u24 v252, 4224, v254
    s_waitcnt lgkmcnt(6)
    v_mfma_f32_32x32x16_bf16 v[192:207], a[128:131], a[132:135], v[192:207]
    ds_read_b128 a[152:155], v226 offset:13664
    ds_read_b128 a[156:159], v227 offset:13664
    v_mfma_f32_32x32x16_bf16 v[144:159], v[80:83], v[92:95], v[144:159]
    ds_read_b128 v[72:75], v13 offset:35840
    ds_read_b128 v[76:79], v13 offset:39936
    buffer_load_dwordx4 v10, s[8:11], s86 offen offset:3072 lds
    s_mul_i32 s30, s98, 8448
    s_lshl_b32 s28, s99, 8
    s_waitcnt lgkmcnt(8)
    v_mfma_f32_32x32x16_bf16 v[192:207], a[136:139], a[140:143], v[192:207]
    ds_read_b128 a[160:163], v226 offset:15616
    ds_read_b128 a[164:167], v227 offset:15616
    v_mfma_f32_32x32x16_bf16 v[160:175], v[84:87], v[88:91], v[160:175]
    ds_read_b64_tr_b16 v[68:69], v20 offset:44032
    ds_read_b64_tr_b16 v[70:71], v20 offset:45056
    s_add_u32 m0, s92, 68608
    s_add_u32 s30, s30, s28
    s_add_u32 s30, s30, 131184
    s_waitcnt lgkmcnt(10)
    v_mfma_f32_32x32x16_bf16 v[192:207], a[144:147], a[148:151], v[192:207]
    ds_read_b128 a[168:171], v226 offset:17568
    ds_read_b128 a[172:175], v227 offset:17568
    s_waitcnt lgkmcnt(8)
    v_mfma_f32_32x32x16_bf16 v[192:207], a[152:155], a[156:159], v[192:207]
    ds_read_b128 a[176:179], v226 offset:19520
    ds_read_b128 a[180:183], v227 offset:19520
    v_mfma_f32_32x32x16_bf16 v[176:191], v[84:87], v[92:95], v[176:191]
    buffer_load_dwordx4 v3, s[4:7], s78 offen offset:0 lds
    v_add3_u32 v23, v251, v252, s30
    v_and_b32 v251, 1, v249
    s_waitcnt lgkmcnt(6)
    v_mfma_f32_32x32x16_bf16 v[192:207], a[160:163], a[164:167], v[192:207]
    ds_read_b128 a[184:187], v226 offset:21472
    ds_read_b128 a[188:191], v227 offset:21472
    s_waitcnt lgkmcnt(6)
    v_mfma_f32_32x32x16_bf16 v[128:143], v[64:67], v[72:75], v[128:143]
    ds_read_b64_tr_b16 v[80:81], v19 offset:48128
    ds_read_b64_tr_b16 v[82:83], v19 offset:49152
    v_lshlrev_b32 v251, 1, v251
    v_xor_b32 v251, v251, v247
    s_waitcnt lgkmcnt(6)
    v_mfma_f32_32x32x16_bf16 v[192:207], a[168:171], a[172:175], v[192:207]
    ds_read_b128 a[192:195], v226 offset:23424
    ds_read_b128 a[196:199], v227 offset:23424
    v_mfma_f32_32x32x16_bf16 v[144:159], v[64:67], v[76:79], v[144:159]
    ds_read_b128 v[88:91], v14 offset:35840
    ds_read_b128 v[92:95], v14 offset:39936
    buffer_load_dwordx4 v4, s[4:7], s78 offen offset:1024 lds
    v_lshl_add_u32 v251, v249, 3, v251
    v_lshl_add_u32 v251, v251, 2, v250
    s_waitcnt lgkmcnt(8)
    v_mfma_f32_32x32x16_bf16 v[192:207], a[176:179], a[180:183], v[192:207]
    ds_read_b128 a[200:203], v226 offset:25376
    ds_read_b128 a[204:207], v227 offset:25376
    s_waitcnt lgkmcnt(8)
    v_mfma_f32_32x32x16_bf16 v[192:207], a[184:187], a[188:191], v[192:207]
    ds_read_b128 a[208:211], v226 offset:27328
    ds_read_b128 a[212:215], v227 offset:27328
    v_mfma_f32_32x32x16_bf16 v[160:175], v[68:71], v[72:75], v[160:175]
    ds_read_b64_tr_b16 v[84:85], v20 offset:48128
    ds_read_b64_tr_b16 v[86:87], v20 offset:49152
    s_mul_i32 s3, s98, 17920
    s_lshl_b32 s28, s99, 10
    s_waitcnt lgkmcnt(8)
    v_mfma_f32_32x32x16_bf16 v[192:207], a[192:195], a[196:199], v[192:207]
    ds_read_b128 a[216:219], v226 offset:29280
    ds_read_b128 a[220:223], v227 offset:29280
    v_mfma_f32_32x32x16_bf16 v[176:191], v[68:71], v[76:79], v[176:191]
    buffer_load_dwordx4 v5, s[4:7], s78 offen offset:2048 lds
    s_add_u32 s29, s3, s28
    v_lshl_add_u32 v24, v251, 4, s29
    s_waitcnt lgkmcnt(6)
    v_mfma_f32_32x32x16_bf16 v[192:207], a[200:203], a[204:207], v[192:207]
    s_waitcnt lgkmcnt(4)
    v_mfma_f32_32x32x16_bf16 v[192:207], a[208:211], a[212:215], v[192:207]
    s_waitcnt lgkmcnt(2)
    v_mfma_f32_32x32x16_bf16 v[128:143], v[80:83], v[88:91], v[128:143]
    s_waitcnt lgkmcnt(0)
    v_mfma_f32_32x32x16_bf16 v[192:207], a[216:219], a[220:223], v[192:207]
    s_waitcnt vmcnt(8)
    s_barrier
    ds_read_b64_tr_b16 v[64:65], v19 offset:0
    ds_read_b64_tr_b16 v[66:67], v19 offset:1024
    v_xor_b32 v25, 128, v24
    s_mul_i32 s29, s99, 768
    v_mfma_f32_32x32x16_bf16 v[144:159], v[80:83], v[92:95], v[144:159]
    ds_read_b128 v[72:75], v11 offset:0
    ds_read_b128 v[76:79], v11 offset:4096
    buffer_load_dwordx4 v6, s[4:7], s78 offen offset:3072 lds
    s_add_u32 s29, s29, s3
    v_min_u32 v251, 47, v1
    v_mfma_f32_32x32x16_bf16 v[160:175], v[84:87], v[88:91], v[160:175]
    ds_read_b64_tr_b16 v[68:69], v20 offset:0
    ds_read_b64_tr_b16 v[70:71], v20 offset:1024
    v_lshl_add_u32 v60, v251, 4, s29
    v_min_u32 v251, 2, v249
    v_mfma_f32_32x32x16_bf16 v[176:191], v[84:87], v[92:95], v[176:191]
    buffer_load_dwordx2 v[30:31], v26, s[24:27], 0 offen sc1
    v_sub_u32 v252, 2, v251
    v_min_u32 v252, v252, v250
    s_waitcnt lgkmcnt(0)
    v_mfma_f32_32x32x16_bf16 v[128:143], v[64:67], v[72:75], v[128:143]
    ds_read_b64_tr_b16 v[80:81], v19 offset:4096
    ds_read_b64_tr_b16 v[82:83], v19 offset:5120
    s_add_u32 m0, s92, 52224
    v_lshl_add_u32 v252, v251, 2, v252
    v_lshl_add_u32 v61, v252, 2, s3
    v_mfma_f32_32x32x16_bf16 v[144:159], v[64:67], v[76:79], v[144:159]
    ds_read_b128 v[88:91], v12 offset:0
    ds_read_b128 v[92:95], v12 offset:4096
    buffer_load_dwordx4 v7, s[8:11], s87 offen offset:0 lds
    s_lshl_b32 s28, s99, 13
    s_add_u32 s93, s28, s3
    v_mfma_f32_32x32x16_bf16 v[160:175], v[68:71], v[72:75], v[160:175]
    ds_read_b64_tr_b16 v[84:85], v20 offset:4096
    ds_read_b64_tr_b16 v[86:87], v20 offset:5120
    s_add_u32 s93, s93, 1536
    s_lshl_b32 s96, s2, 1
    v_mfma_f32_32x32x16_bf16 v[176:191], v[68:71], v[76:79], v[176:191]
    buffer_load_dwordx4 v8, s[8:11], s87 offen offset:1024 lds
    s_add_u32 s96, s96, s98
    s_lshl_b32 s97, s96, 12
    s_waitcnt lgkmcnt(0)
    v_mfma_f32_32x32x16_bf16 v[128:143], v[80:83], v[88:91], v[128:143]
    ds_read_b64_tr_b16 v[64:65], v19 offset:8192
    ds_read_b64_tr_b16 v[66:67], v19 offset:9216
    buffer_load_dwordx4 v9, s[8:11], s87 offen offset:2048 lds
    s_lshl_b32 s28, s99, 11
    s_add_u32 s97, s97, s28
    v_mfma_f32_32x32x16_bf16 v[144:159], v[80:83], v[92:95], v[144:159]
    ds_read_b128 v[72:75], v13 offset:0
    ds_read_b128 v[76:79], v13 offset:4096
    s_add_u32 s28, s97, 65524
    v_lshrrev_b32 v251, 2, v1
    v_mfma_f32_32x32x16_bf16 v[160:175], v[84:87], v[88:91], v[160:175]
    ds_read_b64_tr_b16 v[68:69], v20 offset:8192
    ds_read_b64_tr_b16 v[70:71], v20 offset:9216
    buffer_load_dwordx4 v10, s[8:11], s87 offen offset:3072 lds
    v_xor_b32 v252, 1, v245
    v_lshlrev_b32 v252, 1, v252
    v_mfma_f32_32x32x16_bf16 v[176:191], v[84:87], v[92:95], v[176:191]
    s_add_u32 m0, s92, 35840
    v_xor_b32 v251, v251, v252
    v_lshlrev_b32 v252, 2, v250
    s_waitcnt lgkmcnt(0)
    v_mfma_f32_32x32x16_bf16 v[128:143], v[64:67], v[72:75], v[128:143]
    ds_read_b64_tr_b16 v[80:81], v19 offset:12288
    ds_read_b64_tr_b16 v[82:83], v19 offset:13312
    buffer_load_dwordx4 v3, s[4:7], s79 offen offset:0 lds
    v_lshl_add_u32 v251, v251, 4, v252
    v_add_u32 v32, s28, v251
    v_mfma_f32_32x32x16_bf16 v[144:159], v[64:67], v[76:79], v[144:159]
    ds_read_b128 v[88:91], v14 offset:0
    ds_read_b128 v[92:95], v14 offset:4096
    v_subrev_u32 v33, 768, v32
    v_subrev_u32 v34, 1536, v32
    v_mfma_f32_32x32x16_bf16 v[160:175], v[68:71], v[72:75], v[160:175]
    ds_read_b64_tr_b16 v[84:85], v20 offset:12288
    ds_read_b64_tr_b16 v[86:87], v20 offset:13312
    buffer_load_dwordx4 v4, s[4:7], s79 offen offset:1024 lds
    v_subrev_u32 v35, 2304, v32
    v_lshl_add_u32 v251, v248, 2, v249
    v_mfma_f32_32x32x16_bf16 v[176:191], v[68:71], v[76:79], v[176:191]
    v_lshl_add_u32 v251, v251, 1, v245
    v_lshl_add_u32 v251, v251, 2, v250
    s_waitcnt lgkmcnt(0)
    v_mfma_f32_32x32x16_bf16 v[128:143], v[80:83], v[88:91], v[128:143]
    s_waitcnt vmcnt(7)
    s_barrier
    ds_read_b64_tr_b16 v[64:65], v21 offset:0
    ds_read_b64_tr_b16 v[66:67], v21 offset:1024
    buffer_load_dwordx4 v5, s[4:7], s79 offen offset:2048 lds
    s_add_u32 s28, s97, 2162688
    v_lshl_add_u32 v45, v251, 4, s28
    v_mul_u32_u24 v238, 112, v1
    v_add_u32 v238, v238, v62
    v_mfma_f32_32x32x16_bf16 v[144:159], v[80:83], v[92:95], v[144:159]
    ds_read_b128 v[72:75], v15 offset:0
    ds_read_b128 v[76:79], v15 offset:4096
    s_lshr_b32 s28, s96, 6
    s_lshl_b32 s28, s28, 1
    s_bfm_b64 exec, 32, 0
    buffer_load_dword v239, v238, s[16:19], 0 offen sc1
    s_mov_b64 exec, -1
    v_mfma_f32_32x32x16_bf16 v[160:175], v[84:87], v[88:91], v[160:175]
    ds_read_b64_tr_b16 v[68:69], v22 offset:0
    ds_read_b64_tr_b16 v[70:71], v22 offset:1024
    buffer_load_dwordx4 v6, s[4:7], s79 offen offset:3072 lds
    s_add_u32 s28, s28, s99
    s_lshl_b32 s28, s28, 8
    v_mfma_f32_32x32x16_bf16 v[176:191], v[84:87], v[92:95], v[176:191]
    s_add_u32 m0, s92, 16384
    s_and_b32 s29, s96, 63
    s_lshl_b32 s29, s29, 2
    s_waitcnt lgkmcnt(0)
    v_mfma_f32_32x32x16_bf16 v[128:143], v[64:67], v[72:75], v[128:143]
    ds_read_b64_tr_b16 v[80:81], v21 offset:4096
    ds_read_b64_tr_b16 v[82:83], v21 offset:5120
    buffer_load_dwordx4 v7, s[8:11], s88 offen offset:0 lds
    s_add_u32 s28, s28, s29
    s_add_u32 s75, s28, 8192
    v_mfma_f32_32x32x16_bf16 v[144:159], v[64:67], v[76:79], v[144:159]
    ds_read_b128 v[88:91], v16 offset:0
    ds_read_b128 v[92:95], v16 offset:4096
    s_add_u32 s28, s92, 102400
    v_add_u32 v46, s28, v2
    v_mfma_f32_32x32x16_bf16 v[160:175], v[68:71], v[72:75], v[160:175]
    ds_read_b64_tr_b16 v[84:85], v22 offset:4096
    ds_read_b64_tr_b16 v[86:87], v22 offset:5120
    buffer_load_dwordx4 v8, s[8:11], s88 offen offset:1024 lds
    s_xor_b32 s28, s92, 4096
    s_add_u32 s28, s28, 102400
    v_mfma_f32_32x32x16_bf16 v[176:191], v[68:71], v[76:79], v[176:191]
    v_add_u32 v47, s28, v2
    s_mul_i32 s30, s64, 112
    s_waitcnt lgkmcnt(0)
    v_mfma_f32_32x32x16_bf16 v[128:143], v[80:83], v[88:91], v[128:143]
    ds_read_b64_tr_b16 v[64:65], v21 offset:8192
    ds_read_b64_tr_b16 v[66:67], v21 offset:9216
    buffer_load_dwordx4 v9, s[8:11], s88 offen offset:2048 lds
    s_mul_i32 s28, s60, 28
    s_add_u32 s30, s30, s28
    v_mfma_f32_32x32x16_bf16 v[144:159], v[80:83], v[92:95], v[144:159]
    ds_read_b128 v[72:75], v17 offset:0
    ds_read_b128 v[76:79], v17 offset:4096
    buffer_load_dwordx4 v10, s[8:11], s88 offen offset:3072 lds
    s_lshl_b32 s30, s30, 1
    s_add_u32 s30, s30, s99
    v_mfma_f32_32x32x16_bf16 v[160:175], v[84:87], v[88:91], v[160:175]
    ds_read_b64_tr_b16 v[68:69], v22 offset:8192
    ds_read_b64_tr_b16 v[70:71], v22 offset:9216
    s_add_u32 m0, s92, 0
    s_lshl_b32 s30, s30, 10
    s_add_u32 s30, s30, 5242880
    v_mfma_f32_32x32x16_bf16 v[176:191], v[84:87], v[92:95], v[176:191]
    buffer_load_dwordx4 v3, s[4:7], s80 offen offset:0 lds
    v_add_u32 v43, s30, v2
    v_xor_b32 v44, 1024, v43
    s_waitcnt lgkmcnt(0)
    v_mfma_f32_32x32x16_bf16 v[128:143], v[64:67], v[72:75], v[128:143]
    ds_read_b64_tr_b16 v[80:81], v21 offset:12288
    ds_read_b64_tr_b16 v[82:83], v21 offset:13312
    v_and_b32 v251, 17, v1
    v_bfe_u32 v252, v1, 1, 1
    v_mfma_f32_32x32x16_bf16 v[144:159], v[64:67], v[76:79], v[144:159]
    ds_read_b128 v[88:91], v18 offset:0
    ds_read_b128 v[92:95], v18 offset:4096
    buffer_load_dwordx4 v4, s[4:7], s80 offen offset:1024 lds
    v_lshl_add_u32 v251, v252, 3, v251
    v_lshl_add_u32 v251, v249, 1, v251
    v_mfma_f32_32x32x16_bf16 v[160:175], v[68:71], v[72:75], v[160:175]
    ds_read_b64_tr_b16 v[84:85], v22 offset:12288
    ds_read_b64_tr_b16 v[86:87], v22 offset:13312
    s_lshl_b32 s29, s99, 5
    s_lshl_b32 s28, s64, 6
    v_mfma_f32_32x32x16_bf16 v[176:191], v[68:71], v[76:79], v[176:191]
    buffer_load_dwordx4 v5, s[4:7], s80 offen offset:2048 lds
    s_add_u32 s29, s29, s28
    v_add_u32 v251, s29, v251
    s_waitcnt lgkmcnt(0)
    v_mfma_f32_32x32x16_bf16 v[128:143], v[80:83], v[88:91], v[128:143]
    s_waitcnt vmcnt(7)
    s_barrier
    ds_read_b64_tr_b16 v[64:65], v19 offset:35840
    ds_read_b64_tr_b16 v[66:67], v19 offset:36864
    v_lshlrev_b32 v50, 2, v251
    v_add_u32 v50, 16384, v50
    v_mfma_f32_32x32x16_bf16 v[144:159], v[80:83], v[92:95], v[144:159]
    ds_read_b128 v[72:75], v11 offset:35840
    ds_read_b128 v[76:79], v11 offset:39936
    buffer_load_dwordx4 v6, s[4:7], s80 offen offset:3072 lds
    s_lshl_b32 s28, s98, 6
    s_lshl_b32 s29, s65, 7
    s_bfm_b64 exec, 32, 32
    buffer_load_dword v239, v238, s[16:19], 0 offen sc1
    s_mov_b64 exec, -1
    v_mfma_f32_32x32x16_bf16 v[160:175], v[84:87], v[88:91], v[160:175]
    ds_read_b64_tr_b16 v[68:69], v20 offset:35840
    ds_read_b64_tr_b16 v[70:71], v20 offset:36864
    s_add_u32 m0, s92, 84992
    s_add_u32 s28, s28, s29
    v_lshl_add_u32 v252, v245, 4, s28
    v_mfma_f32_32x32x16_bf16 v[176:191], v[84:87], v[92:95], v[176:191]
    buffer_load_dwordx4 v7, s[8:11], s89 offen offset:0 lds
    v_lshl_add_u32 v51, v251, 10, v252
    s_lshr_b32 s30, s2, 6
    s_waitcnt lgkmcnt(0)
    v_mfma_f32_32x32x16_bf16 v[128:143], v[64:67], v[72:75], v[128:143]
    ds_read_b64_tr_b16 v[80:81], v19 offset:39936
    ds_read_b64_tr_b16 v[82:83], v19 offset:40960
    s_lshl_b32 s30, s30, 3
    s_add_u32 s30, s30, s61
    v_mfma_f32_32x32x16_bf16 v[144:159], v[64:67], v[76:79], v[144:159]
    ds_read_b128 v[88:91], v12 offset:35840
    ds_read_b128 v[92:95], v12 offset:39936
    buffer_load_dwordx4 v8, s[8:11], s89 offen offset:1024 lds
    s_lshl_b32 s30, s30, 7
    v_lshl_add_u32 v57, v244, 2, s30
    v_mfma_f32_32x32x16_bf16 v[160:175], v[68:71], v[72:75], v[160:175]
    ds_read_b64_tr_b16 v[84:85], v20 offset:39936
    ds_read_b64_tr_b16 v[86:87], v20 offset:40960
    s_lshl_b32 s30, s64, 2
    s_add_u32 s30, s30, s60
    v_mov_b32 v112, v195
    v_mov_b32 v113, v195
    v_mfma_f32_32x32x16_bf16 v[176:191], v[68:71], v[76:79], v[176:191]
    buffer_load_dwordx4 v9, s[8:11], s89 offen offset:2048 lds
    s_lshl_b32 s30, s30, 8
    s_add_u32 s30, s30, 32768
    v_cndmask_b32 v96, v201, v202, s[66:67]
    v_cndmask_b32 v97, v200, v201, s[66:67]
    s_waitcnt lgkmcnt(0)
    v_mfma_f32_32x32x16_bf16 v[128:143], v[80:83], v[88:91], v[128:143]
    ds_read_b64_tr_b16 v[64:65], v19 offset:44032
    ds_read_b64_tr_b16 v[66:67], v19 offset:45056
    v_min_u32 v251, 6, v1
    v_lshl_add_u32 v58, v251, 2, s30
    v_permlane32_swap_b32 v112, v113
    v_cvt_pk_bf16_f32 v100, v202, v96
    v_mfma_f32_32x32x16_bf16 v[144:159], v[80:83], v[92:95], v[144:159]
    ds_read_b128 v[72:75], v13 offset:35840
    ds_read_b128 v[76:79], v13 offset:39936
    buffer_load_dwordx4 v10, s[8:11], s89 offen offset:3072 lds
    s_add_u32 s30, s30, 128
    v_min_u32 v251, 7, v1
    v_cvt_pk_bf16_f32 v101, v201, v201
    v_cvt_pk_bf16_f32 v102, v97, v200
    v_mfma_f32_32x32x16_bf16 v[160:175], v[84:87], v[88:91], v[160:175]
    ds_read_b64_tr_b16 v[68:69], v20 offset:44032
    ds_read_b64_tr_b16 v[70:71], v20 offset:45056
    s_add_u32 m0, s92, 68608
    v_lshl_add_u32 v40, v251, 2, s30
    s_lshr_b32 s28, s64, 4
    v_cvt_pk_bf16_f32 v103, v200, v200
    v_mov_b32_dpp v114, v113 wave_ror:1 row_mask:0xf bank_mask:0xf
    v_mfma_f32_32x32x16_bf16 v[176:191], v[84:87], v[92:95], v[176:191]
    buffer_load_dwordx4 v3, s[4:7], s81 offen offset:0 lds
    s_lshl_b32 s30, s65, 1
    s_add_u32 s30, s30, s28
    v_mov_b32_dpp v112, v113 wave_shr:1 row_mask:0x3 bank_mask:0xf bound_ctrl:0
    v_add_f32 v192, v192, v228
    s_waitcnt lgkmcnt(0)
    v_mfma_f32_32x32x16_bf16 v[128:143], v[64:67], v[72:75], v[128:143]
    ds_read_b64_tr_b16 v[80:81], v19 offset:48128
    ds_read_b64_tr_b16 v[82:83], v19 offset:49152
    buffer_load_dwordx4 v4, s[4:7], s81 offen offset:1024 lds
    s_lshl_b32 s30, s30, 8
    s_add_u32 s30, s30, 8192
    v_cndmask_b32 v96, v204, v205, s[68:69]
    v_cndmask_b32 v97, v204, v205, s[70:71]
    v_mfma_f32_32x32x16_bf16 v[144:159], v[64:67], v[76:79], v[144:159]
    ds_read_b128 v[88:91], v14 offset:35840
    ds_read_b128 v[92:95], v14 offset:39936
    s_lshl_b32 s28, s60, 6
    s_add_u32 s30, s30, s28
    v_cvt_pk_bf16_f32 v104, v205, v205
    v_cvt_pk_bf16_f32 v105, v96, v97
    v_mfma_f32_32x32x16_bf16 v[160:175], v[68:71], v[72:75], v[160:175]
    ds_read_b64_tr_b16 v[84:85], v20 offset:48128
    ds_read_b64_tr_b16 v[86:87], v20 offset:49152
    buffer_load_dwordx4 v5, s[4:7], s81 offen offset:2048 lds
    v_lshl_add_u32 v59, v246, 2, s30
    s_xor_b32 s28, s60, 0
    v_cvt_pk_bf16_f32 v106, v204, v204
    v_cvt_pk_bf16_f32 v107, v204, v204
    v_mfma_f32_32x32x16_bf16 v[176:191], v[68:71], v[76:79], v[176:191]
    s_mul_i32 s29, s28, 12288
    s_lshr_b32 s28, s28, 1
    v_cndmask_b32 v96, v206, v207, s[68:69]
    v_cndmask_b32 v97, v206, v207, s[70:71]
    s_waitcnt lgkmcnt(0)
    v_mfma_f32_32x32x16_bf16 v[128:143], v[80:83], v[88:91], v[128:143]
    s_waitcnt vmcnt(8)
    s_barrier
    ds_read_b64_tr_b16 v[64:65], v19 offset:0
    ds_read_b64_tr_b16 v[66:67], v19 offset:1024
    buffer_load_dwordx4 v6, s[4:7], s81 offen offset:3072 lds
    s_mul_i32 s28, s28, 94208
    s_add_u32 s29, s29, s28
    v_cvt_pk_bf16_f32 v108, v207, v207
    v_cvt_pk_bf16_f32 v109, v96, v97
    v_mfma_f32_32x32x16_bf16 v[144:159], v[80:83], v[92:95], v[144:159]
    ds_read_b128 v[72:75], v11 offset:0
    ds_read_b128 v[76:79], v11 offset:4096
    s_add_u32 m0, s92, 52224
    v_add_u32 v55, s29, v2
    s_xor_b32 s28, s60, 1
    v_cvt_pk_bf16_f32 v110, v206, v206
    v_cvt_pk_bf16_f32 v111, v206, v206
    v_mfma_f32_32x32x16_bf16 v[160:175], v[84:87], v[88:91], v[160:175]
    ds_read_b64_tr_b16 v[68:69], v20 offset:0
    ds_read_b64_tr_b16 v[70:71], v20 offset:1024
    buffer_load_dwordx4 v7, s[8:11], s90 offen offset:0 lds
    s_mul_i32 s29, s28, 12288
    s_lshr_b32 s28, s28, 1
    v_cmp_eq_u32 vcc, 0, v229
    s_nop 1
    v_cndmask_b32 v114, v196, v114, vcc
    v_cndmask_b32 v98, v197, v198, s[66:67]
    v_mfma_f32_32x32x16_bf16 v[176:191], v[84:87], v[92:95], v[176:191]
    s_mul_i32 s28, s28, 94208
    s_add_u32 s29, s29, s28
    v_cndmask_b32 v99, v196, v197, s[66:67]
    v_cvt_pk_bf16_f32 v96, v98, v99
    s_waitcnt lgkmcnt(0)
    v_mfma_f32_32x32x16_bf16 v[128:143], v[64:67], v[72:75], v[128:143]
    ds_read_b64_tr_b16 v[80:81], v19 offset:4096
    ds_read_b64_tr_b16 v[82:83], v19 offset:5120
    buffer_load_dwordx4 v8, s[8:11], s90 offen offset:1024 lds
    s_add_u32 s29, s29, 0
    v_add_u32 v52, s29, v2
    v_cvt_pk_bf16_f32 v97, v196, v114
    v_cndmask_b32 v98, v194, v195, s[66:67]
    v_mfma_f32_32x32x16_bf16 v[144:159], v[64:67], v[76:79], v[144:159]
    ds_read_b128 v[88:91], v12 offset:0
    ds_read_b128 v[92:95], v12 offset:4096
    s_xor_b32 s28, s60, 2
    s_mul_i32 s29, s28, 12288
    v_cndmask_b32 v99, v193, v194, s[66:67]
    v_cndmask_b32 v113, v192, v193, s[66:67]
    v_mfma_f32_32x32x16_bf16 v[160:175], v[68:71], v[72:75], v[160:175]
    ds_read_b64_tr_b16 v[84:85], v20 offset:4096
    ds_read_b64_tr_b16 v[86:87], v20 offset:5120
    buffer_load_dwordx4 v9, s[8:11], s90 offen offset:2048 lds
    s_lshr_b32 s28, s28, 1
    s_mul_i32 s28, s28, 94208
    v_cndmask_b32 v112, v112, v192, s[66:67]
    v_cvt_pk_bf16_f32 v98, v98, v99
    v_mfma_f32_32x32x16_bf16 v[176:191], v[68:71], v[76:79], v[176:191]
    s_add_u32 s29, s29, s28
    s_add_u32 s29, s29, 4096
    v_cvt_pk_bf16_f32 v99, v113, v112
    v_permlane32_swap_b32 v98, v96
    s_waitcnt lgkmcnt(0)
    v_mfma_f32_32x32x16_bf16 v[128:143], v[80:83], v[88:91], v[128:143]
    ds_read_b64_tr_b16 v[64:65], v19 offset:8192
    ds_read_b64_tr_b16 v[66:67], v19 offset:9216
    buffer_load_dwordx4 v10, s[8:11], s90 offen offset:3072 lds
    v_add_u32 v53, s29, v2
    s_xor_b32 s28, s60, 3
    v_permlane32_swap_b32 v99, v97
    v_mfma_f32_32x32x16_bf16 v[144:159], v[80:83], v[92:95], v[144:159]
    ds_read_b128 v[72:75], v13 offset:0
    ds_read_b128 v[76:79], v13 offset:4096
    s_add_u32 m0, s92, 35840
    s_mul_i32 s29, s28, 12288
    s_lshr_b32 s28, s28, 1
    v_mfma_f32_32x32x16_bf16 v[160:175], v[84:87], v[88:91], v[160:175]
    ds_read_b64_tr_b16 v[68:69], v20 offset:8192
    ds_read_b64_tr_b16 v[70:71], v20 offset:9216
    buffer_load_dwordx4 v3, s[4:7], s82 offen offset:0 lds
    s_mul_i32 s28, s28, 94208
    s_add_u32 s29, s29, s28
    v_mfma_f32_32x32x16_bf16 v[176:191], v[84:87], v[92:95], v[176:191]
    s_add_u32 s29, s29, 8192
    v_add_u32 v54, s29, v2
    s_waitcnt lgkmcnt(0)
    v_mfma_f32_32x32x16_bf16 v[128:143], v[64:67], v[72:75], v[128:143]
    ds_read_b64_tr_b16 v[80:81], v19 offset:12288
    ds_read_b64_tr_b16 v[82:83], v19 offset:13312
    buffer_load_dwordx4 v4, s[4:7], s82 offen offset:1024 lds
    s_mov_b32 s34, 131072
    s_mov_b32 s35, 196608
    v_mfma_f32_32x32x16_bf16 v[144:159], v[64:67], v[76:79], v[144:159]
    ds_read_b128 v[88:91], v14 offset:0
    ds_read_b128 v[92:95], v14 offset:4096
    s_mov_b32 s36, 262144
    s_mov_b32 s37, 327680
    v_mfma_f32_32x32x16_bf16 v[160:175], v[68:71], v[72:75], v[160:175]
    ds_read_b64_tr_b16 v[84:85], v20 offset:12288
    ds_read_b64_tr_b16 v[86:87], v20 offset:13312
    buffer_load_dwordx4 v5, s[4:7], s82 offen offset:2048 lds
    s_mov_b32 s38, 393216
    s_mov_b32 s47, 8192
    v_mfma_f32_32x32x16_bf16 v[176:191], v[68:71], v[76:79], v[176:191]
    s_mov_b32 s48, 16384
    s_mov_b32 s49, 24576
    s_waitcnt lgkmcnt(0)
    v_mfma_f32_32x32x16_bf16 v[128:143], v[80:83], v[88:91], v[128:143]
    s_waitcnt vmcnt(7)
    s_barrier
    ds_read_b64_tr_b16 v[64:65], v21 offset:0
    ds_read_b64_tr_b16 v[66:67], v21 offset:1024
    buffer_load_dwordx4 v6, s[4:7], s82 offen offset:3072 lds
    s_add_u32 m0, s92, 16384
    s_mov_b32 s50, 32768
    s_mov_b32 s51, 40960
    v_mfma_f32_32x32x16_bf16 v[144:159], v[80:83], v[92:95], v[144:159]
    ds_read_b128 v[72:75], v15 offset:0
    ds_read_b128 v[76:79], v15 offset:4096
    buffer_load_dwordx4 v7, s[8:11], s91 offen offset:0 lds
    s_mov_b32 s52, 49152
    v_mfma_f32_32x32x16_bf16 v[160:175], v[84:87], v[88:91], v[160:175]
    ds_read_b64_tr_b16 v[68:69], v22 offset:0
    ds_read_b64_tr_b16 v[70:71], v22 offset:1024
    v_mfma_f32_32x32x16_bf16 v[176:191], v[84:87], v[92:95], v[176:191]
    buffer_load_dwordx4 v8, s[8:11], s91 offen offset:1024 lds
    s_waitcnt lgkmcnt(0)
    v_mfma_f32_32x32x16_bf16 v[128:143], v[64:67], v[72:75], v[128:143]
    ds_read_b64_tr_b16 v[80:81], v21 offset:4096
    ds_read_b64_tr_b16 v[82:83], v21 offset:5120
    v_mfma_f32_32x32x16_bf16 v[144:159], v[64:67], v[76:79], v[144:159]
    ds_read_b128 v[88:91], v16 offset:0
    ds_read_b128 v[92:95], v16 offset:4096
    buffer_load_dwordx4 v9, s[8:11], s91 offen offset:2048 lds
    v_mfma_f32_32x32x16_bf16 v[160:175], v[68:71], v[72:75], v[160:175]
    ds_read_b64_tr_b16 v[84:85], v22 offset:4096
    ds_read_b64_tr_b16 v[86:87], v22 offset:5120
    v_mfma_f32_32x32x16_bf16 v[176:191], v[68:71], v[76:79], v[176:191]
    buffer_load_dwordx4 v10, s[8:11], s91 offen offset:3072 lds
    s_waitcnt lgkmcnt(0)
    v_mfma_f32_32x32x16_bf16 v[128:143], v[80:83], v[88:91], v[128:143]
    ds_read_b64_tr_b16 v[64:65], v21 offset:8192
    ds_read_b64_tr_b16 v[66:67], v21 offset:9216
    s_add_u32 m0, s92, 0
    v_mfma_f32_32x32x16_bf16 v[144:159], v[80:83], v[92:95], v[144:159]
    ds_read_b128 v[72:75], v17 offset:0
    ds_read_b128 v[76:79], v17 offset:4096
    buffer_load_dwordx4 v3, s[4:7], s83 offen offset:0 lds
    v_mfma_f32_32x32x16_bf16 v[160:175], v[84:87], v[88:91], v[160:175]
    ds_read_b64_tr_b16 v[68:69], v22 offset:8192
    ds_read_b64_tr_b16 v[70:71], v22 offset:9216
    v_mfma_f32_32x32x16_bf16 v[176:191], v[84:87], v[92:95], v[176:191]
    buffer_load_dwordx4 v4, s[4:7], s83 offen offset:1024 lds
    s_waitcnt lgkmcnt(0)
    v_mfma_f32_32x32x16_bf16 v[128:143], v[64:67], v[72:75], v[128:143]
    ds_read_b64_tr_b16 v[80:81], v21 offset:12288
    ds_read_b64_tr_b16 v[82:83], v21 offset:13312
    v_mfma_f32_32x32x16_bf16 v[144:159], v[64:67], v[76:79], v[144:159]
    ds_read_b128 v[88:91], v18 offset:0
    ds_read_b128 v[92:95], v18 offset:4096
    buffer_load_dwordx4 v5, s[4:7], s83 offen offset:2048 lds
    v_mfma_f32_32x32x16_bf16 v[160:175], v[68:71], v[72:75], v[160:175]
    ds_read_b64_tr_b16 v[84:85], v22 offset:12288
    ds_read_b64_tr_b16 v[86:87], v22 offset:13312
    v_cmp_eq_u32 vcc, 0, v31
    s_nop 1
    s_cbranch_vccnz slow_1
ret_2:
    v_readfirstlane_b32 s63, v30
    v_mov_b32 v29, v30
    v_mfma_f32_32x32x16_bf16 v[176:191], v[68:71], v[76:79], v[176:191]
    buffer_load_dwordx4 v6, s[4:7], s83 offen offset:3072 lds
    s_waitcnt lgkmcnt(0)
    v_mfma_f32_32x32x16_bf16 v[128:143], v[80:83], v[88:91], v[128:143]
    s_waitcnt vmcnt(8)
    s_barrier
    ds_read_b64_tr_b16 v[64:65], v19 offset:35840
    ds_read_b64_tr_b16 v[66:67], v19 offset:36864
    s_add_u32 m0, s92, 68608
    v_mfma_f32_32x32x16_bf16 v[144:159], v[80:83], v[92:95], v[144:159]
    ds_read_b128 v[72:75], v11 offset:35840
    ds_read_b128 v[76:79], v11 offset:39936
    buffer_load_dwordx4 v36, s[12:15], 0 offen offset:0 lds
    v_mfma_f32_32x32x16_bf16 v[160:175], v[84:87], v[88:91], v[160:175]
    ds_read_b64_tr_b16 v[68:69], v20 offset:35840
    ds_read_b64_tr_b16 v[70:71], v20 offset:36864
    v_mfma_f32_32x32x16_bf16 v[176:191], v[84:87], v[92:95], v[176:191]
    s_waitcnt lgkmcnt(0)
    v_mfma_f32_32x32x16_bf16 v[128:143], v[64:67], v[72:75], v[128:143]
    ds_read_b64_tr_b16 v[80:81], v19 offset:39936
    ds_read_b64_tr_b16 v[82:83], v19 offset:40960
    buffer_load_dwordx4 v37, s[12:15], 0 offen offset:1024 lds
    v_mfma_f32_32x32x16_bf16 v[144:159], v[64:67], v[76:79], v[144:159]
    ds_read_b128 v[88:91], v12 offset:35840
    ds_read_b128 v[92:95], v12 offset:39936
    v_mfma_f32_32x32x16_bf16 v[160:175], v[68:71], v[72:75], v[160:175]
    ds_read_b64_tr_b16 v[84:85], v20 offset:39936
    ds_read_b64_tr_b16 v[86:87], v20 offset:40960
    buffer_load_dwordx4 v28, s[12:15], 0 offen offset:2048 lds
    v_mfma_f32_32x32x16_bf16 v[176:191], v[68:71], v[76:79], v[176:191]
    s_waitcnt lgkmcnt(0)
    v_mfma_f32_32x32x16_bf16 v[128:143], v[80:83], v[88:91], v[128:143]
    ds_read_b64_tr_b16 v[64:65], v19 offset:44032
    ds_read_b64_tr_b16 v[66:67], v19 offset:45056
    buffer_load_dwordx4 v42, s[12:15], 0 offen offset:3072 lds
    v_mfma_f32_32x32x16_bf16 v[144:159], v[80:83], v[92:95], v[144:159]
    ds_read_b128 v[72:75], v13 offset:35840
    ds_read_b128 v[76:79], v13 offset:39936
    v_mfma_f32_32x32x16_bf16 v[160:175], v[84:87], v[88:91], v[160:175]
    ds_read_b64_tr_b16 v[68:69], v20 offset:44032
    ds_read_b64_tr_b16 v[70:71], v20 offset:45056
    s_add_u32 m0, s92, 84992
    v_mfma_f32_32x32x16_bf16 v[176:191], v[84:87], v[92:95], v[176:191]
    buffer_load_dwordx4 v36, s[12:15], s33 offen offset:0 lds
    s_waitcnt lgkmcnt(0)
    v_mfma_f32_32x32x16_bf16 v[128:143], v[64:67], v[72:75], v[128:143]
    ds_read_b64_tr_b16 v[80:81], v19 offset:48128
    ds_read_b64_tr_b16 v[82:83], v19 offset:49152
    v_mfma_f32_32x32x16_bf16 v[144:159], v[64:67], v[76:79], v[144:159]
    ds_read_b128 v[88:91], v14 offset:35840
    ds_read_b128 v[92:95], v14 offset:39936
    buffer_load_dwordx4 v37, s[12:15], s33 offen offset:1024 lds
    v_mfma_f32_32x32x16_bf16 v[160:175], v[68:71], v[72:75], v[160:175]
    ds_read_b64_tr_b16 v[84:85], v20 offset:48128
    ds_read_b64_tr_b16 v[86:87], v20 offset:49152
    v_mfma_f32_32x32x16_bf16 v[176:191], v[68:71], v[76:79], v[176:191]
    buffer_load_dwordx4 v28, s[12:15], s33 offen offset:2048 lds
    s_waitcnt lgkmcnt(0)
    v_mfma_f32_32x32x16_bf16 v[128:143], v[80:83], v[88:91], v[128:143]
    s_waitcnt vmcnt(7)
    s_barrier
    ds_read_b64_tr_b16 v[64:65], v19 offset:0
    ds_read_b64_tr_b16 v[66:67], v19 offset:1024
    ds_read_b128 v[72:75], v11 offset:0
    v_mfma_f32_32x32x16_bf16 v[144:159], v[80:83], v[92:95], v[144:159]
    ds_read_b64_tr_b16 v[208:209], v19 offset:4096
    ds_read_b64_tr_b16 v[210:211], v19 offset:5120
    ds_read_b128 v[216:219], v12 offset:0
    v_mfma_f32_32x32x16_bf16 v[160:175], v[84:87], v[88:91], v[160:175]
    ds_read_b64_tr_b16 v[112:113], v19 offset:8192
    ds_read_b64_tr_b16 v[114:115], v19 offset:9216
    ds_read_b128 v[120:123], v13 offset:0
    buffer_load_dwordx4 v42, s[12:15], s33 offen offset:3072 lds
    v_mfma_f32_32x32x16_bf16 v[176:191], v[84:87], v[92:95], v[176:191]
    ds_read_b64_tr_b16 v[80:81], v19 offset:12288
    ds_read_b64_tr_b16 v[82:83], v19 offset:13312
    ds_read_b128 v[88:91], v14 offset:0
    s_add_u32 m0, s92, 35840
    s_waitcnt lgkmcnt(9)
    v_mfma_f32_32x32x16_bf16 v[128:143], v[64:67], v[72:75], v[128:143]
    ds_read_b128 v[76:79], v11 offset:4096
    ds_read_b128 v[220:223], v12 offset:4096
    ds_read_b128 v[124:127], v13 offset:4096
    buffer_load_dwordx4 v36, s[12:15], s34 offen offset:0 lds
    s_waitcnt lgkmcnt(9)
    v_mfma_f32_32x32x16_bf16 v[128:143], v[208:211], v[216:219], v[128:143]
    ds_read_b128 v[92:95], v14 offset:4096
    ds_read_b64_tr_b16 v[68:69], v20 offset:0
    ds_read_b64_tr_b16 v[70:71], v20 offset:1024
    s_waitcnt lgkmcnt(9)
    v_mfma_f32_32x32x16_bf16 v[128:143], v[112:115], v[120:123], v[128:143]
    ds_read_b64_tr_b16 v[212:213], v20 offset:4096
    ds_read_b64_tr_b16 v[214:215], v20 offset:5120
    ds_read_b64_tr_b16 v[116:117], v20 offset:8192
    buffer_load_dwordx4 v37, s[12:15], s34 offen offset:1024 lds
    s_waitcnt lgkmcnt(9)
    v_mfma_f32_32x32x16_bf16 v[128:143], v[80:83], v[88:91], v[128:143]
    ds_read_b64_tr_b16 v[118:119], v20 offset:9216
    ds_read_b64_tr_b16 v[84:85], v20 offset:12288
    ds_read_b64_tr_b16 v[86:87], v20 offset:13312
    s_mov_b32 s30, 0xbfb8aa3b
    v_mov_b32 v252, s30
    v_mov_b32 v253, s30
    s_mov_b32 s96, 4096
    s_waitcnt lgkmcnt(11)
    v_mfma_f32_32x32x16_bf16 v[144:159], v[64:67], v[76:79], v[144:159]
    s_nop 2
    v_pk_mul_f32 v[244:245], v[128:129], v[252:253]
    v_pk_mul_f32 v[246:247], v[130:131], v[252:253]
    v_pk_mul_f32 v[248:249], v[132:133], v[252:253]
    v_pk_mul_f32 v[250:251], v[134:135], v[252:253]
    v_exp_f32 v244, v244
    buffer_load_dwordx4 v28, s[12:15], s34 offen offset:2048 lds
    v_exp_f32 v245, v245
    s_waitcnt lgkmcnt(10)
    v_mfma_f32_32x32x16_bf16 v[144:159], v[208:211], v[220:223], v[144:159]
    v_exp_f32 v246, v246
    v_exp_f32 v247, v247
    buffer_load_dwordx4 v42, s[12:15], s34 offen offset:3072 lds
    v_exp_f32 v248, v248
    s_waitcnt lgkmcnt(9)
    v_mfma_f32_32x32x16_bf16 v[144:159], v[112:115], v[124:127], v[144:159]
    v_exp_f32 v249, v249
    v_exp_f32 v250, v250
    s_add_u32 m0, s92, 52224
    v_exp_f32 v251, v251
    s_waitcnt lgkmcnt(8)
    v_mfma_f32_32x32x16_bf16 v[144:159], v[80:83], v[92:95], v[144:159]
    buffer_load_dwordx4 v36, s[12:15], s35 offen offset:0 lds
    v_pk_add_f32 v[244:245], v[244:245], 1.0 op_sel_hi:[1,0]
    v_pk_add_f32 v[246:247], v[246:247], 1.0 op_sel_hi:[1,0]
    v_pk_add_f32 v[248:249], v[248:249], 1.0 op_sel_hi:[1,0]
    v_pk_add_f32 v[250:251], v[250:251], 1.0 op_sel_hi:[1,0]
    v_rcp_f32 v244, v244
    v_rcp_f32 v245, v245
    v_rcp_f32 v246, v246
    s_waitcnt lgkmcnt(6)
    v_mfma_f32_32x32x16_bf16 v[160:175], v[68:71], v[72:75], v[160:175]
    buffer_load_dword v63, v57, s[16:19], 0 offen sc1
    v_rcp_f32 v247, v247
    buffer_load_dwordx4 v37, s[12:15], s35 offen offset:1024 lds
    v_rcp_f32 v248, v248
    v_rcp_f32 v249, v249
    s_waitcnt lgkmcnt(4)
    v_mfma_f32_32x32x16_bf16 v[160:175], v[212:215], v[216:219], v[160:175]
    v_rcp_f32 v250, v250
    v_rcp_f32 v251, v251
    buffer_load_dwordx4 v28, s[12:15], s35 offen offset:2048 lds
    v_pk_mul_f32 v[244:245], v[244:245], v[128:129]
    v_pk_mul_f32 v[246:247], v[246:247], v[130:131]
    v_pk_mul_f32 v[248:249], v[248:249], v[132:133]
    v_pk_mul_f32 v[250:251], v[250:251], v[134:135]
    v_cvt_pk_bf16_f32 v192, v244, v245
    v_cvt_pk_bf16_f32 v193, v246, v247
    v_cvt_pk_bf16_f32 v194, v248, v249
    v_cvt_pk_bf16_f32 v195, v250, v251
    v_pk_mul_f32 v[244:245], v[136:137], v[252:253]
    v_pk_mul_f32 v[246:247], v[138:139], v[252:253]
    v_pk_mul_f32 v[248:249], v[140:141], v[252:253]
    v_pk_mul_f32 v[250:251], v[142:143], v[252:253]
    v_exp_f32 v244, v244
    s_waitcnt lgkmcnt(2)
    v_mfma_f32_32x32x16_bf16 v[160:175], v[116:119], v[120:123], v[160:175]
    buffer_store_dwordx4 v[192:195], v62, s[16:19], 0 offen offset:0 sc1
    v_exp_f32 v245, v245
    v_exp_f32 v246, v246
    s_waitcnt vmcnt(13)
    ds_read_b64_tr_b16 a[0:1], v38 offset:32768
    v_exp_f32 v247, v247
    s_waitcnt lgkmcnt(1)
    v_mfma_f32_32x32x16_bf16 v[160:175], v[84:87], v[88:91], v[160:175]
    s_barrier
    ds_read_b64_tr_b16 a[2:3], v38 offset:33792
    v_exp_f32 v248, v248
    ds_read_b64_tr_b16 a[4:5], v39 offset:32768
    v_exp_f32 v249, v249
    ds_read_b64_tr_b16 a[6:7], v39 offset:33792
    v_exp_f32 v250, v250
    v_mfma_f32_32x32x16_bf16 v[176:191], v[68:71], v[76:79], v[176:191]
    ds_read_b64_tr_b16 a[8:9], v38 offset:34816
    v_exp_f32 v251, v251
    ds_read_b64_tr_b16 a[10:11], v38 offset:35840
    v_pk_add_f32 v[244:245], v[244:245], 1.0 op_sel_hi:[1,0]
    v_pk_add_f32 v[246:247], v[246:247], 1.0 op_sel_hi:[1,0]
    v_pk_add_f32 v[248:249], v[248:249], 1.0 op_sel_hi:[1,0]
    v_pk_add_f32 v[250:251], v[250:251], 1.0 op_sel_hi:[1,0]
    v_rcp_f32 v244, v244
    buffer_load_dwordx4 v42, s[12:15], s35 offen offset:3072 lds
    ds_read_b64_tr_b16 a[12:13], v39 offset:34816
    v_rcp_f32 v245, v245
    v_mfma_f32_32x32x16_bf16 v[176:191], v[212:215], v[220:223], v[176:191]
    ds_read_b64_tr_b16 a[14:15], v39 offset:35840
    v_rcp_f32 v246, v246
    v_rcp_f32 v247, v247
    s_add_u32 m0, s92, 68608
    v_rcp_f32 v248, v248
    v_mfma_f32_32x32x16_bf16 v[176:191], v[116:119], v[124:127], v[176:191]
    s_waitcnt lgkmcnt(0)
    buffer_load_dwordx4 v36, s[12:15], s36 offen offset:0 lds
    v_rcp_f32 v249, v249
    v_rcp_f32 v250, v250
    v_rcp_f32 v251, v251
    v_mfma_f32_32x32x16_bf16 v[176:191], v[84:87], v[92:95], v[176:191]
    v_pk_mul_f32 v[244:245], v[244:245], v[136:137]
    v_pk_mul_f32 v[246:247], v[246:247], v[138:139]
    v_pk_mul_f32 v[248:249], v[248:249], v[140:141]
    v_pk_mul_f32 v[250:251], v[250:251], v[142:143]
    v_cvt_pk_bf16_f32 v196, v244, v245
    v_cvt_pk_bf16_f32 v197, v246, v247
    v_cvt_pk_bf16_f32 v198, v248, v249
    v_cvt_pk_bf16_f32 v199, v250, v251
    v_pk_mul_f32 v[244:245], v[144:145], v[252:253]
    v_pk_mul_f32 v[246:247], v[146:147], v[252:253]
    v_pk_mul_f32 v[248:249], v[148:149], v[252:253]
    v_pk_mul_f32 v[250:251], v[150:151], v[252:253]
    v_exp_f32 v244, v244
    buffer_store_dwordx4 v[196:199], v62, s[16:19], 0 offen offset:2048 sc1
    buffer_load_dwordx4 v37, s[12:15], s36 offen offset:1024 lds
    v_exp_f32 v245, v245
    v_exp_f32 v246, v246
    v_exp_f32 v247, v247
    v_exp_f32 v248, v248
    v_exp_f32 v249, v249
    v_exp_f32 v250, v250
    v_exp_f32 v251, v251
    v_pk_add_f32 v[244:245], v[244:245], 1.0 op_sel_hi:[1,0]
    v_pk_add_f32 v[246:247], v[246:247], 1.0 op_sel_hi:[1,0]
    v_pk_add_f32 v[248:249], v[248:249], 1.0 op_sel_hi:[1,0]
    v_pk_add_f32 v[250:251], v[250:251], 1.0 op_sel_hi:[1,0]
    v_rcp_f32 v244, v244
    v_rcp_f32 v245, v245
    buffer_load_dwordx4 v28, s[12:15], s36 offen offset:2048 lds
    v_rcp_f32 v246, v246
    v_rcp_f32 v247, v247
    v_rcp_f32 v248, v248
    v_rcp_f32 v249, v249
    buffer_load_dwordx4 v42, s[12:15], s36 offen offset:3072 lds
    v_rcp_f32 v250, v250
    v_rcp_f32 v251, v251
    v_pk_mul_f32 v[244:245], v[244:245], v[144:145]
    v_pk_mul_f32 v[246:247], v[246:247], v[146:147]
    v_pk_mul_f32 v[248:249], v[248:249], v[148:149]
    v_pk_mul_f32 v[250:251], v[250:251], v[150:151]
    v_cvt_pk_bf16_f32 v200, v244, v245
    v_cvt_pk_bf16_f32 v201, v246, v247
    v_cvt_pk_bf16_f32 v202, v248, v249
    v_cvt_pk_bf16_f32 v203, v250, v251
    v_pk_mul_f32 v[244:245], v[152:153], v[252:253]
    v_pk_mul_f32 v[246:247], v[154:155], v[252:253]
    v_pk_mul_f32 v[248:249], v[156:157], v[252:253]
    v_pk_mul_f32 v[250:251], v[158:159], v[252:253]
    v_exp_f32 v244, v244
    buffer_store_dwordx4 v[200:203], v62, s[16:19], 0 offen offset:1024 sc1
    v_exp_f32 v245, v245
    v_exp_f32 v246, v246
    v_exp_f32 v247, v247
    v_exp_f32 v248, v248
    v_exp_f32 v249, v249
    s_add_u32 m0, s93, 0
    v_exp_f32 v250, v250
    s_waitcnt vmcnt(10)
    v_cmp_ne_u32 vcc, s63, v63
    s_nop 1
    s_cbranch_vccnz slow_4
ret_5:
    ds_write_b128 v60, v[240:243]
    s_mov_b32 s97, 0
    buffer_load_dwordx4 v32, s[16:19], s97 offen offset:0 sc1 lds
    v_exp_f32 v251, v251
    v_pk_add_f32 v[244:245], v[244:245], 1.0 op_sel_hi:[1,0]
    v_pk_add_f32 v[246:247], v[246:247], 1.0 op_sel_hi:[1,0]
    v_pk_add_f32 v[248:249], v[248:249], 1.0 op_sel_hi:[1,0]
    v_pk_add_f32 v[250:251], v[250:251], 1.0 op_sel_hi:[1,0]
    v_rcp_f32 v244, v244
    v_rcp_f32 v245, v245
    buffer_load_dwordx4 v33, s[16:19], s97 offen offset:1024 sc1 lds
    v_rcp_f32 v246, v246
    v_rcp_f32 v247, v247
    v_rcp_f32 v248, v248
    buffer_load_dwordx4 v34, s[16:19], s97 offen offset:2048 sc1 lds
    v_rcp_f32 v249, v249
    v_rcp_f32 v250, v250
    ds_write_b128 v224, v[240:243] offset:4192
    v_rcp_f32 v251, v251
    buffer_load_dwordx4 v35, s[16:19], s97 offen offset:3072 sc1 lds
    v_pk_mul_f32 v[244:245], v[244:245], v[152:153]
    v_pk_mul_f32 v[246:247], v[246:247], v[154:155]
    v_pk_mul_f32 v[248:249], v[248:249], v[156:157]
    v_pk_mul_f32 v[250:251], v[250:251], v[158:159]
    v_cvt_pk_bf16_f32 v204, v244, v245
    v_cvt_pk_bf16_f32 v205, v246, v247
    v_cvt_pk_bf16_f32 v206, v248, v249
    v_cvt_pk_bf16_f32 v207, v250, v251
    v_pk_mul_f32 v[244:245], v[160:161], v[252:253]
    v_pk_mul_f32 v[246:247], v[162:163], v[252:253]
    v_pk_mul_f32 v[248:249], v[164:165], v[252:253]
    v_pk_mul_f32 v[250:251], v[166:167], v[252:253]
    v_exp_f32 v244, v244
    buffer_store_dwordx4 v[204:207], v62, s[16:19], 0 offen offset:3072 sc1
    v_exp_f32 v245, v245
    s_add_u32 m0, s93, 4096
    v_exp_f32 v246, v246
    s_mov_b32 s97, 1024
    buffer_load_dwordx4 v32, s[16:19], s97 offen offset:0 sc1 lds
    v_exp_f32 v247, v247
    v_exp_f32 v248, v248
    ds_read_b64_tr_b16 a[16:17], v38 offset:49152
    v_exp_f32 v249, v249
    buffer_load_dwordx4 v33, s[16:19], s97 offen offset:1024 sc1 lds
    ds_read_b64_tr_b16 a[18:19], v38 offset:50176
    v_exp_f32 v250, v250
    ds_write_b128 v224, v[100:103] offset:3056
    ds_read_b64_tr_b16 a[20:21], v39 offset:49152
    v_exp_f32 v251, v251
    ds_read_b64_tr_b16 a[22:23], v39 offset:50176
    v_pk_add_f32 v[244:245], v[244:245], 1.0 op_sel_hi:[1,0]
    v_pk_add_f32 v[246:247], v[246:247], 1.0 op_sel_hi:[1,0]
    v_pk_add_f32 v[248:249], v[248:249], 1.0 op_sel_hi:[1,0]
    v_pk_add_f32 v[250:251], v[250:251], 1.0 op_sel_hi:[1,0]
    v_rcp_f32 v244, v244
    buffer_load_dwordx4 v34, s[16:19], s97 offen offset:2048 sc1 lds
    ds_read_b64_tr_b16 a[24:25], v38 offset:51200
    v_rcp_f32 v245, v245
    ds_read_b64_tr_b16 a[26:27], v38 offset:52224
    v_rcp_f32 v246, v246
    ds_read_b64_tr_b16 a[28:29], v39 offset:51200
    v_rcp_f32 v247, v247
    buffer_load_dwordx4 v35, s[16:19], s97 offen offset:3072 sc1 lds
    ds_read_b64_tr_b16 a[30:31], v39 offset:52224
    v_rcp_f32 v248, v248
    v_rcp_f32 v249, v249
    s_add_u32 m0, s92, 84992
    v_rcp_f32 v250, v250
    ds_write_b128 v225, v[104:107] offset:2032
    s_waitcnt lgkmcnt(1)
    buffer_load_dwordx4 v36, s[12:15], s37 offen offset:0 lds
    v_rcp_f32 v251, v251
    v_pk_mul_f32 v[244:245], v[244:245], v[160:161]
    v_pk_mul_f32 v[246:247], v[246:247], v[162:163]
    v_pk_mul_f32 v[248:249], v[248:249], v[164:165]
    v_pk_mul_f32 v[250:251], v[250:251], v[166:167]
    v_cvt_pk_bf16_f32 v208, v244, v245
    v_cvt_pk_bf16_f32 v209, v246, v247
    v_cvt_pk_bf16_f32 v210, v248, v249
    v_cvt_pk_bf16_f32 v211, v250, v251
    v_pk_mul_f32 v[244:245], v[168:169], v[252:253]
    v_pk_mul_f32 v[246:247], v[170:171], v[252:253]
    v_pk_mul_f32 v[248:249], v[172:173], v[252:253]
    v_pk_mul_f32 v[250:251], v[174:175], v[252:253]
    v_exp_f32 v244, v244
    buffer_store_dwordx4 v[208:211], v62, s[16:19], s96 offen offset:0 sc1
    v_exp_f32 v245, v245
    v_exp_f32 v246, v246
    v_exp_f32 v247, v247
    v_exp_f32 v248, v248
    v_exp_f32 v249, v249
    v_exp_f32 v250, v250
    ds_write_b128 v225, v[108:111] offset:1520
    v_exp_f32 v251, v251
    v_pk_add_f32 v[244:245], v[244:245], 1.0 op_sel_hi:[1,0]
    v_pk_add_f32 v[246:247], v[246:247], 1.0 op_sel_hi:[1,0]
    v_pk_add_f32 v[248:249], v[248:249], 1.0 op_sel_hi:[1,0]
    v_pk_add_f32 v[250:251], v[250:251], 1.0 op_sel_hi:[1,0]
    v_rcp_f32 v244, v244
    v_rcp_f32 v245, v245
    v_rcp_f32 v246, v246
    v_rcp_f32 v247, v247
    v_rcp_f32 v248, v248
    buffer_load_dwordx4 v37, s[12:15], s37 offen offset:1024 lds
    v_rcp_f32 v249, v249
    v_rcp_f32 v250, v250
    ds_write_b128 v224, v[96:99] offset:4080
    v_rcp_f32 v251, v251
    v_pk_mul_f32 v[244:245], v[244:245], v[168:169]
    v_pk_mul_f32 v[246:247], v[246:247], v[170:171]
    v_pk_mul_f32 v[248:249], v[248:249], v[172:173]
    v_pk_mul_f32 v[250:251], v[250:251], v[174:175]
    v_cvt_pk_bf16_f32 v212, v244, v245
    v_cvt_pk_bf16_f32 v213, v246, v247
    v_cvt_pk_bf16_f32 v214, v248, v249
    v_cvt_pk_bf16_f32 v215, v250, v251
    v_pk_mul_f32 v[244:245], v[176:177], v[252:253]
    v_pk_mul_f32 v[246:247], v[178:179], v[252:253]
    v_pk_mul_f32 v[248:249], v[180:181], v[252:253]
    v_pk_mul_f32 v[250:251], v[182:183], v[252:253]
    v_exp_f32 v244, v244
    buffer_store_dwordx4 v[212:215], v62, s[16:19], s96 offen offset:2048 sc1
    buffer_load_dwordx4 v28, s[12:15], s37 offen offset:2048 lds
    v_exp_f32 v245, v245
    v_exp_f32 v246, v246
    v_exp_f32 v247, v247
    ds_read_b64_tr_b16 a[32:33], v38 offset:0
    v_exp_f32 v248, v248
    ds_read_b64_tr_b16 a[34:35], v38 offset:1024
    v_exp_f32 v249, v249
    ds_read_b64_tr_b16 a[36:37], v39 offset:0
    v_exp_f32 v250, v250
    ds_read_b64_tr_b16 a[38:39], v39 offset:1024
    v_exp_f32 v251, v251
    ds_read_b64_tr_b16 a[40:41], v38 offset:2048
    v_pk_add_f32 v[244:245], v[244:245], 1.0 op_sel_hi:[1,0]
    v_pk_add_f32 v[246:247], v[246:247], 1.0 op_sel_hi:[1,0]
    v_pk_add_f32 v[248:249], v[248:249], 1.0 op_sel_hi:[1,0]
    v_pk_add_f32 v[250:251], v[250:251], 1.0 op_sel_hi:[1,0]
    v_rcp_f32 v244, v244
    ds_read_b64_tr_b16 a[42:43], v38 offset:3072
    v_rcp_f32 v245, v245
    buffer_load_dwordx4 v42, s[12:15], s37 offen offset:3072 lds
    ds_read_b64_tr_b16 a[44:45], v39 offset:2048
    v_rcp_f32 v246, v246
    ds_read_b64_tr_b16 a[46:47], v39 offset:3072
    v_rcp_f32 v247, v247
    v_rcp_f32 v248, v248
    s_add_u32 m0, s92, 35840
    v_rcp_f32 v249, v249
    s_waitcnt vmcnt(10)
    s_mov_b64 exec, 1
    buffer_store_dword v29, v26, s[16:19], s74 offen offset:0 sc1
    s_mov_b64 exec, -1
    s_waitcnt lgkmcnt(0)
    buffer_load_dwordx4 v36, s[12:15], s38 offen offset:0 lds
    v_add_u32 v36, 32768, v36
    v_rcp_f32 v250, v250
    v_rcp_f32 v251, v251
    v_pk_mul_f32 v[244:245], v[244:245], v[176:177]
    v_pk_mul_f32 v[246:247], v[246:247], v[178:179]
    v_pk_mul_f32 v[248:249], v[248:249], v[180:181]
    v_pk_mul_f32 v[250:251], v[250:251], v[182:183]
    v_cvt_pk_bf16_f32 v216, v244, v245
    v_cvt_pk_bf16_f32 v217, v246, v247
    v_cvt_pk_bf16_f32 v218, v248, v249
    v_cvt_pk_bf16_f32 v219, v250, v251
    v_pk_mul_f32 v[244:245], v[184:185], v[252:253]
    v_pk_mul_f32 v[246:247], v[186:187], v[252:253]
    v_pk_mul_f32 v[248:249], v[188:189], v[252:253]
    v_pk_mul_f32 v[250:251], v[190:191], v[252:253]
    v_exp_f32 v244, v244
    buffer_store_dwordx4 v[216:219], v62, s[16:19], s96 offen offset:1024 sc1
    v_exp_f32 v245, v245
    v_exp_f32 v246, v246
    v_exp_f32 v247, v247
    v_exp_f32 v248, v248
    v_exp_f32 v249, v249
    v_exp_f32 v250, v250
    buffer_load_dwordx4 v37, s[12:15], s38 offen offset:1024 lds
    v_add_u32 v37, 32768, v37
    v_exp_f32 v251, v251
    ds_read_b64_tr_b16 a[48:49], v38 offset:16384
    v_pk_add_f32 v[244:245], v[244:245], 1.0 op_sel_hi:[1,0]
    v_pk_add_f32 v[246:247], v[246:247], 1.0 op_sel_hi:[1,0]
    v_pk_add_f32 v[248:249], v[248:249], 1.0 op_sel_hi:[1,0]
    v_pk_add_f32 v[250:251], v[250:251], 1.0 op_sel_hi:[1,0]
    v_rcp_f32 v244, v244
    s_waitcnt vmcnt(10)
    ds_write_b32 v61, v26 offset:1664
    s_waitcnt lgkmcnt(0)
    s_barrier
    ds_read_b128 v[64:67], v23 offset:3584
    ds_read_b128 v[96:99], v24 offset:0
    ds_read_b64_tr_b16 a[50:51], v38 offset:17408
    v_rcp_f32 v245, v245
    ds_read_b128 v[68:71], v23 offset:3072
    ds_read_b128 v[100:103], v24 offset:2048
    ds_read_b64_tr_b16 a[52:53], v39 offset:16384
    v_rcp_f32 v246, v246
    ds_read_b128 v[72:75], v23 offset:2560
    ds_read_b128 v[104:107], v24 offset:4096
    buffer_load_dwordx4 v28, s[12:15], s38 offen offset:2048 lds
    v_add_u32 v28, 32768, v28
    ds_read_b64_tr_b16 a[54:55], v39 offset:17408
    v_rcp_f32 v247, v247
    ds_read_b128 v[76:79], v23 offset:2048
    ds_read_b128 v[108:111], v24 offset:6144
    ds_read_b64_tr_b16 a[56:57], v38 offset:18432
    v_rcp_f32 v248, v248
    ds_read_b128 v[80:83], v23 offset:1536
    ds_read_b128 v[112:115], v24 offset:8192
    ds_read_b64_tr_b16 a[58:59], v38 offset:19456
    v_rcp_f32 v249, v249
    ds_read_b128 v[84:87], v23 offset:1024
    ds_read_b128 v[116:119], v24 offset:10240
    ds_read_b64_tr_b16 a[60:61], v39 offset:18432
    v_rcp_f32 v250, v250
    ds_read_b128 v[88:91], v23 offset:512
    ds_read_b128 v[120:123], v24 offset:12288
    buffer_load_dwordx4 v42, s[12:15], s38 offen offset:3072 lds
    v_add_u32 v42, 32768, v42
    ds_read_b64_tr_b16 a[62:63], v39 offset:19456
    v_rcp_f32 v251, v251
    ds_read_b128 v[92:95], v23 offset:0
    ds_read_b128 v[124:127], v24 offset:14336
    v_pk_mul_f32 v[244:245], v[244:245], v[184:185]
    v_pk_mul_f32 v[246:247], v[246:247], v[186:187]
    v_pk_mul_f32 v[248:249], v[248:249], v[188:189]
    v_pk_mul_f32 v[250:251], v[250:251], v[190:191]
    v_cvt_pk_bf16_f32 v220, v244, v245
    v_cvt_pk_bf16_f32 v221, v246, v247
    v_cvt_pk_bf16_f32 v222, v248, v249
    v_cvt_pk_bf16_f32 v223, v250, v251
L_conv:
    s_waitcnt lgkmcnt(15)
    v_mfma_f32_16x16x32_bf16 a[224:227], v[64:67], v[96:99], 0
    buffer_store_dwordx4 v[220:223], v62, s[16:19], s96 offen offset:3072 sc1
    s_waitcnt lgkmcnt(2)
    s_add_u32 m0, s92, 52224
    s_nop 0
    buffer_load_dwordx4 v36, s[12:15], 0 offen offset:0 lds
    v_mfma_f32_16x16x32_bf16 a[228:231], v[64:67], v[100:103], 0
    ds_read_b128 v[128:131], v23 offset:3648
    v_mfma_f32_16x16x32_bf16 a[228:231], v[68:71], v[96:99], a[228:231]
    v_mfma_f32_16x16x32_bf16 a[232:235], v[68:71], v[100:103], 0
    ds_read_b128 v[160:163], v24 offset:256
    v_mfma_f32_16x16x32_bf16 a[232:235], v[64:67], v[104:107], a[232:235]
    buffer_load_dwordx4 v37, s[12:15], 0 offen offset:1024 lds
    v_mfma_f32_16x16x32_bf16 a[236:239], v[68:71], v[104:107], 0
    ds_read_b128 v[132:135], v23 offset:3136
    v_mfma_f32_16x16x32_bf16 a[232:235], v[72:75], v[96:99], a[232:235]
    ds_read_b64_tr_b16 a[64:65], v38 offset:32768
    v_mfma_f32_16x16x32_bf16 a[236:239], v[72:75], v[100:103], a[236:239]
    ds_read_b64_tr_b16 a[66:67], v38 offset:33792
    ds_read_b128 v[164:167], v24 offset:2304
    v_mfma_f32_16x16x32_bf16 a[240:243], v[72:75], v[104:107], 0
    buffer_load_dwordx4 v28, s[12:15], 0 offen offset:2048 lds
    ds_read_b64_tr_b16 a[68:69], v39 offset:32768
    v_mfma_f32_16x16x32_bf16 a[236:239], v[64:67], v[108:111], a[236:239]
    ds_read_b64_tr_b16 a[70:71], v39 offset:33792
    ds_read_b128 v[136:139], v23 offset:2624
    v_mfma_f32_16x16x32_bf16 a[240:243], v[68:71], v[108:111], a[240:243]
    ds_read_b64_tr_b16 a[72:73], v38 offset:34816
    v_mfma_f32_16x16x32_bf16 a[244:247], v[72:75], v[108:111], 0
    ds_read_b64_tr_b16 a[74:75], v38 offset:35840
    ds_read_b128 v[168:171], v24 offset:4352
    v_mfma_f32_16x16x32_bf16 a[236:239], v[76:79], v[96:99], a[236:239]
    buffer_load_dwordx4 v42, s[12:15], 0 offen offset:3072 lds
    ds_read_b64_tr_b16 a[76:77], v39 offset:34816
    v_mfma_f32_16x16x32_bf16 a[240:243], v[76:79], v[100:103], a[240:243]
    ds_read_b64_tr_b16 a[78:79], v39 offset:35840
    ds_read_b128 v[140:143], v23 offset:2112
    v_mfma_f32_16x16x32_bf16 a[244:247], v[76:79], v[104:107], a[244:247]
    v_mfma_f32_16x16x32_bf16 a[248:251], v[76:79], v[108:111], 0
    s_add_u32 m0, s92, 68608
    ds_read_b128 v[172:175], v24 offset:6400
    v_mfma_f32_16x16x32_bf16 a[240:243], v[64:67], v[112:115], a[240:243]
    s_waitcnt lgkmcnt(2)
    buffer_load_dwordx4 v36, s[12:15], s33 offen offset:0 lds
    v_mfma_f32_16x16x32_bf16 a[244:247], v[68:71], v[112:115], a[244:247]
    ds_read_b128 v[144:147], v23 offset:1600
    v_mfma_f32_16x16x32_bf16 a[248:251], v[72:75], v[112:115], a[248:251]
    v_mfma_f32_16x16x32_bf16 a[252:255], v[76:79], v[112:115], 0
    ds_read_b128 v[176:179], v24 offset:8448
    v_mfma_f32_16x16x32_bf16 a[240:243], v[80:83], v[96:99], a[240:243]
    v_mfma_f32_16x16x32_bf16 a[244:247], v[80:83], v[100:103], a[244:247]
    buffer_load_dwordx4 v37, s[12:15], s33 offen offset:1024 lds
    ds_read_b128 v[148:151], v23 offset:1088
    v_mfma_f32_16x16x32_bf16 a[248:251], v[80:83], v[104:107], a[248:251]
    v_mfma_f32_16x16x32_bf16 a[252:255], v[80:83], v[108:111], a[252:255]
    ds_read_b128 v[180:183], v24 offset:10496
    v_mfma_f32_16x16x32_bf16 a[244:247], v[64:67], v[116:119], a[244:247]
    s_waitcnt vmcnt(13)
    ds_read_b64_tr_b16 a[80:81], v38 offset:49152
    v_mfma_f32_16x16x32_bf16 a[248:251], v[68:71], v[116:119], a[248:251]
    buffer_load_dwordx4 v28, s[12:15], s33 offen offset:2048 lds
    ds_read_b64_tr_b16 a[82:83], v38 offset:50176
    ds_read_b128 v[152:155], v23 offset:576
    v_mfma_f32_16x16x32_bf16 a[252:255], v[72:75], v[116:119], a[252:255]
    ds_read_b64_tr_b16 a[84:85], v39 offset:49152
    v_mfma_f32_16x16x32_bf16 a[244:247], v[84:87], v[96:99], a[244:247]
    ds_read_b64_tr_b16 a[86:87], v39 offset:50176
    ds_read_b128 v[184:187], v24 offset:12544
    v_mfma_f32_16x16x32_bf16 a[248:251], v[84:87], v[100:103], a[248:251]
    ds_read_b64_tr_b16 a[88:89], v38 offset:51200
    v_mfma_f32_16x16x32_bf16 a[252:255], v[84:87], v[104:107], a[252:255]
    buffer_load_dwordx4 v42, s[12:15], s33 offen offset:3072 lds
    ds_read_b64_tr_b16 a[90:91], v38 offset:52224
    ds_read_b128 v[156:159], v23 offset:64
    v_mfma_f32_16x16x32_bf16 a[248:251], v[64:67], v[120:123], a[248:251]
    ds_read_b64_tr_b16 a[92:93], v39 offset:51200
    v_mfma_f32_16x16x32_bf16 a[252:255], v[68:71], v[120:123], a[252:255]
    ds_read_b64_tr_b16 a[94:95], v39 offset:52224
    ds_read_b128 v[188:191], v24 offset:14592
    v_mfma_f32_16x16x32_bf16 a[248:251], v[88:91], v[96:99], a[248:251]
    v_mfma_f32_16x16x32_bf16 a[252:255], v[88:91], v[100:103], a[252:255]
    s_add_u32 m0, s92, 84992
    v_mfma_f32_16x16x32_bf16 a[252:255], v[64:67], v[124:127], a[252:255]
    s_waitcnt lgkmcnt(1)
    buffer_load_dwordx4 v36, s[12:15], s34 offen offset:0 lds
    v_mfma_f32_16x16x32_bf16 a[252:255], v[92:95], v[96:99], a[252:255]
    v_mfma_f32_16x16x32_bf16 a[224:227], v[128:131], v[160:163], a[224:227]
    v_mfma_f32_16x16x32_bf16 a[228:231], v[128:131], v[164:167], a[228:231]
    ds_read_b128 v[64:67], v23 offset:3712
    v_mfma_f32_16x16x32_bf16 a[228:231], v[132:135], v[160:163], a[228:231]
    buffer_load_dwordx4 v37, s[12:15], s34 offen offset:1024 lds
    v_mfma_f32_16x16x32_bf16 a[232:235], v[132:135], v[164:167], a[232:235]
    ds_read_b128 v[96:99], v25 offset:512
    v_mfma_f32_16x16x32_bf16 a[232:235], v[128:131], v[168:171], a[232:235]
    v_mfma_f32_16x16x32_bf16 a[236:239], v[132:135], v[168:171], a[236:239]
    s_waitcnt vmcnt(10)
    s_mov_b64 exec, 1
    buffer_store_dword v29, v26, s[16:19], s74 offen offset:128 sc1
    s_mov_b64 exec, -1
    ds_read_b64_tr_b16 a[96:97], v38 offset:0
    ds_read_b128 v[68:71], v23 offset:3200
    v_mfma_f32_16x16x32_bf16 a[232:235], v[136:139], v[160:163], a[232:235]
    buffer_load_dwordx4 v28, s[12:15], s34 offen offset:2048 lds
    ds_read_b64_tr_b16 a[98:99], v38 offset:1024
    v_mfma_f32_16x16x32_bf16 a[236:239], v[136:139], v[164:167], a[236:239]
    ds_read_b64_tr_b16 a[100:101], v39 offset:0
    ds_read_b128 v[100:103], v25 offset:2560
    v_mfma_f32_16x16x32_bf16 a[240:243], v[136:139], v[168:171], a[240:243]
    ds_read_b64_tr_b16 a[102:103], v39 offset:1024
    v_mfma_f32_16x16x32_bf16 a[236:239], v[128:131], v[172:175], a[236:239]
    ds_read_b64_tr_b16 a[104:105], v38 offset:2048
    ds_read_b128 v[72:75], v23 offset:2688
    v_mfma_f32_16x16x32_bf16 a[240:243], v[132:135], v[172:175], a[240:243]
    ds_read_b64_tr_b16 a[106:107], v38 offset:3072
    v_mfma_f32_16x16x32_bf16 a[244:247], v[136:139], v[172:175], a[244:247]
    buffer_load_dwordx4 v42, s[12:15], s34 offen offset:3072 lds
    ds_read_b64_tr_b16 a[108:109], v39 offset:2048
    ds_read_b128 v[104:107], v25 offset:4608
    v_mfma_f32_16x16x32_bf16 a[236:239], v[140:143], v[160:163], a[236:239]
    ds_read_b64_tr_b16 a[110:111], v39 offset:3072
    v_mfma_f32_16x16x32_bf16 a[240:243], v[140:143], v[164:167], a[240:243]
    ds_read_b128 v[76:79], v23 offset:2176
    v_mfma_f32_16x16x32_bf16 a[244:247], v[140:143], v[168:171], a[244:247]
    s_add_u32 m0, s92, 35840
    v_mfma_f32_16x16x32_bf16 a[248:251], v[140:143], v[172:175], a[248:251]
    s_waitcnt lgkmcnt(1)
    buffer_load_dwordx4 v36, s[12:15], s35 offen offset:0 lds
    ds_read_b128 v[108:111], v25 offset:6656
    v_mfma_f32_16x16x32_bf16 a[240:243], v[128:131], v[176:179], a[240:243]
    v_mfma_f32_16x16x32_bf16 a[244:247], v[132:135], v[176:179], a[244:247]
    ds_read_b128 v[80:83], v23 offset:1664
    v_mfma_f32_16x16x32_bf16 a[248:251], v[136:139], v[176:179], a[248:251]
    buffer_load_dword v63, v58, s[16:19], 0 offen sc1
    v_mfma_f32_16x16x32_bf16 a[252:255], v[140:143], v[176:179], a[252:255]
    buffer_load_dwordx4 v37, s[12:15], s35 offen offset:1024 lds
    ds_read_b128 v[112:115], v25 offset:8704
    v_mfma_f32_16x16x32_bf16 a[240:243], v[144:147], v[160:163], a[240:243]
    v_mfma_f32_16x16x32_bf16 a[244:247], v[144:147], v[164:167], a[244:247]
    ds_read_b128 v[84:87], v23 offset:1152
    v_mfma_f32_16x16x32_bf16 a[248:251], v[144:147], v[168:171], a[248:251]
    s_waitcnt vmcnt(12)
    ds_read_b64_tr_b16 a[112:113], v38 offset:16384
    v_mfma_f32_16x16x32_bf16 a[252:255], v[144:147], v[172:175], a[252:255]
    ds_read_b64_tr_b16 a[114:115], v38 offset:17408
    ds_read_b128 v[116:119], v25 offset:10752
    v_mfma_f32_16x16x32_bf16 a[244:247], v[128:131], v[180:183], a[244:247]
    buffer_load_dwordx4 v28, s[12:15], s35 offen offset:2048 lds
    ds_read_b64_tr_b16 a[116:117], v39 offset:16384
    v_mfma_f32_16x16x32_bf16 a[248:251], v[132:135], v[180:183], a[248:251]
    ds_read_b64_tr_b16 a[118:119], v39 offset:17408
    ds_read_b128 v[88:91], v23 offset:640
    v_mfma_f32_16x16x32_bf16 a[252:255], v[136:139], v[180:183], a[252:255]
    ds_read_b64_tr_b16 a[120:121], v38 offset:18432
    v_mfma_f32_16x16x32_bf16 a[244:247], v[148:151], v[160:163], a[244:247]
    ds_read_b64_tr_b16 a[122:123], v38 offset:19456
    ds_read_b128 v[120:123], v25 offset:12800
    v_mfma_f32_16x16x32_bf16 a[248:251], v[148:151], v[164:167], a[248:251]
    buffer_load_dwordx4 v42, s[12:15], s35 offen offset:3072 lds
    ds_read_b64_tr_b16 a[124:125], v39 offset:18432
    v_mfma_f32_16x16x32_bf16 a[252:255], v[148:151], v[168:171], a[252:255]
    ds_read_b64_tr_b16 a[126:127], v39 offset:19456
    ds_read_b128 v[92:95], v23 offset:128
    v_mfma_f32_16x16x32_bf16 a[248:251], v[128:131], v[184:187], a[248:251]
    v_mfma_f32_16x16x32_bf16 a[252:255], v[132:135], v[184:187], a[252:255]
    s_add_u32 m0, s92, 52224
    ds_read_b128 v[124:127], v25 offset:14848
    v_mfma_f32_16x16x32_bf16 a[248:251], v[152:155], v[160:163], a[248:251]
    s_waitcnt lgkmcnt(2)
    buffer_load_dwordx4 v36, s[12:15], s36 offen offset:0 lds
    v_mfma_f32_16x16x32_bf16 a[252:255], v[152:155], v[164:167], a[252:255]
    v_mfma_f32_16x16x32_bf16 a[252:255], v[128:131], v[188:191], a[252:255]
    v_mfma_f32_16x16x32_bf16 a[252:255], v[156:159], v[160:163], a[252:255]
    v_mfma_f32_16x16x32_bf16 a[224:227], v[64:67], v[96:99], a[224:227]
    v_mfma_f32_16x16x32_bf16 a[228:231], v[64:67], v[100:103], a[228:231]
    buffer_load_dwordx4 v37, s[12:15], s36 offen offset:1024 lds
    ds_read_b128 v[128:131], v23 offset:3776
    v_mfma_f32_16x16x32_bf16 a[228:231], v[68:71], v[96:99], a[228:231]
    v_mfma_f32_16x16x32_bf16 a[232:235], v[68:71], v[100:103], a[232:235]
    ds_read_b128 v[160:163], v25 offset:768
    v_mfma_f32_16x16x32_bf16 a[232:235], v[64:67], v[104:107], a[232:235]
    s_waitcnt vmcnt(12)
    ds_read_b64_tr_b16 a[128:129], v38 offset:32768
    v_mfma_f32_16x16x32_bf16 a[236:239], v[68:71], v[104:107], a[236:239]
    buffer_load_dwordx4 v28, s[12:15], s36 offen offset:2048 lds
    ds_read_b64_tr_b16 a[130:131], v38 offset:33792
    ds_read_b128 v[132:135], v23 offset:3264
    v_mfma_f32_16x16x32_bf16 a[232:235], v[72:75], v[96:99], a[232:235]
    ds_read_b64_tr_b16 a[132:133], v39 offset:32768
    v_mfma_f32_16x16x32_bf16 a[236:239], v[72:75], v[100:103], a[236:239]
    ds_read_b64_tr_b16 a[134:135], v39 offset:33792
    ds_read_b128 v[164:167], v25 offset:2816
    v_mfma_f32_16x16x32_bf16 a[240:243], v[72:75], v[104:107], a[240:243]
    ds_read_b64_tr_b16 a[136:137], v38 offset:34816
    v_mfma_f32_16x16x32_bf16 a[236:239], v[64:67], v[108:111], a[236:239]
    buffer_load_dwordx4 v42, s[12:15], s36 offen offset:3072 lds
    ds_read_b64_tr_b16 a[138:139], v38 offset:35840
    ds_read_b128 v[136:139], v23 offset:2752
    v_mfma_f32_16x16x32_bf16 a[240:243], v[68:71], v[108:111], a[240:243]
    ds_read_b64_tr_b16 a[140:141], v39 offset:34816
    v_mfma_f32_16x16x32_bf16 a[244:247], v[72:75], v[108:111], a[244:247]
    ds_read_b64_tr_b16 a[142:143], v39 offset:35840
    ds_read_b128 v[168:171], v25 offset:4864
    v_mfma_f32_16x16x32_bf16 a[236:239], v[76:79], v[96:99], a[236:239]
    v_mfma_f32_16x16x32_bf16 a[240:243], v[76:79], v[100:103], a[240:243]
    s_add_u32 m0, s92, 68608
    ds_read_b128 v[140:143], v23 offset:2240
    v_mfma_f32_16x16x32_bf16 a[244:247], v[76:79], v[104:107], a[244:247]
    s_waitcnt lgkmcnt(2)
    buffer_load_dwordx4 v36, s[12:15], s37 offen offset:0 lds
    v_mfma_f32_16x16x32_bf16 a[248:251], v[76:79], v[108:111], a[248:251]
    ds_read_b128 v[172:175], v25 offset:6912
    v_mfma_f32_16x16x32_bf16 a[240:243], v[64:67], v[112:115], a[240:243]
    v_mfma_f32_16x16x32_bf16 a[244:247], v[68:71], v[112:115], a[244:247]
    ds_read_b128 v[144:147], v23 offset:1728
    v_mfma_f32_16x16x32_bf16 a[248:251], v[72:75], v[112:115], a[248:251]
    buffer_load_dwordx4 v37, s[12:15], s37 offen offset:1024 lds
    v_mfma_f32_16x16x32_bf16 a[252:255], v[76:79], v[112:115], a[252:255]
    ds_read_b128 v[176:179], v25 offset:8960
    v_mfma_f32_16x16x32_bf16 a[240:243], v[80:83], v[96:99], a[240:243]
    v_mfma_f32_16x16x32_bf16 a[244:247], v[80:83], v[100:103], a[244:247]
    ds_read_b128 v[148:151], v23 offset:1216
    v_mfma_f32_16x16x32_bf16 a[248:251], v[80:83], v[104:107], a[248:251]
    buffer_load_dwordx4 v28, s[12:15], s37 offen offset:2048 lds
    v_mfma_f32_16x16x32_bf16 a[252:255], v[80:83], v[108:111], a[252:255]
    ds_read_b128 v[180:183], v25 offset:11008
    v_mfma_f32_16x16x32_bf16 a[244:247], v[64:67], v[116:119], a[244:247]
    v_mfma_f32_16x16x32_bf16 a[248:251], v[68:71], v[116:119], a[248:251]
    ds_read_b128 v[152:155], v23 offset:704
    v_mfma_f32_16x16x32_bf16 a[252:255], v[72:75], v[116:119], a[252:255]
    v_mfma_f32_16x16x32_bf16 a[244:247], v[84:87], v[96:99], a[244:247]
    buffer_load_dwordx4 v42, s[12:15], s37 offen offset:3072 lds
    ds_read_b128 v[184:187], v25 offset:13056
    v_mfma_f32_16x16x32_bf16 a[248:251], v[84:87], v[100:103], a[248:251]
    v_mfma_f32_16x16x32_bf16 a[252:255], v[84:87], v[104:107], a[252:255]
    ds_read_b128 v[156:159], v23 offset:192
    v_mfma_f32_16x16x32_bf16 a[248:251], v[64:67], v[120:123], a[248:251]
    v_mfma_f32_16x16x32_bf16 a[252:255], v[68:71], v[120:123], a[252:255]
    s_waitcnt vmcnt(11)
    v_cmp_ne_u32 vcc, s63, v63
    s_nop 1
    s_cbranch_vccnz slow_7
ret_8:
    buffer_load_dwordx4 v[192:195], v43, s[16:19], 0 offen offset:0 sc1
    ds_read_b128 v[188:191], v25 offset:15104
    v_mfma_f32_16x16x32_bf16 a[248:251], v[88:91], v[96:99], a[248:251]
    v_mfma_f32_16x16x32_bf16 a[252:255], v[88:91], v[100:103], a[252:255]
    v_mfma_f32_16x16x32_bf16 a[252:255], v[64:67], v[124:127], a[252:255]
    v_mfma_f32_16x16x32_bf16 a[252:255], v[92:95], v[96:99], a[252:255]
    buffer_load_dwordx4 v[196:199], v44, s[16:19], 0 offen offset:0 sc1
    v_mfma_f32_16x16x32_bf16 a[224:227], v[128:131], v[160:163], a[224:227]
    v_mfma_f32_16x16x32_bf16 a[228:231], v[128:131], v[164:167], a[228:231]
    v_mfma_f32_16x16x32_bf16 a[228:231], v[132:135], v[160:163], a[228:231]
    buffer_load_dwordx4 v[200:203], v43, s[16:19], 0 offen offset:2048 sc1
    v_mfma_f32_16x16x32_bf16 a[232:235], v[132:135], v[164:167], a[232:235]
    s_waitcnt lgkmcnt(10)
    v_mfma_f32_16x16x32_bf16 a[232:235], v[128:131], v[168:171], a[232:235]
    v_mfma_f32_16x16x32_bf16 a[236:239], v[132:135], v[168:171], a[236:239]
    v_mfma_f32_16x16x32_bf16 a[232:235], v[136:139], v[160:163], a[232:235]
    buffer_load_dwordx4 v[204:207], v44, s[16:19], 0 offen offset:2048 sc1
    v_mfma_f32_16x16x32_bf16 a[236:239], v[136:139], v[164:167], a[236:239]
    v_mfma_f32_16x16x32_bf16 a[240:243], v[136:139], v[168:171], a[240:243]
    s_waitcnt lgkmcnt(8)
    v_mfma_f32_16x16x32_bf16 a[236:239], v[128:131], v[172:175], a[236:239]
    v_mfma_f32_16x16x32_bf16 a[240:243], v[132:135], v[172:175], a[240:243]
    buffer_load_dwordx4 v[208:211], v43, s[16:19], s47 offen offset:0 sc1
    v_mfma_f32_16x16x32_bf16 a[244:247], v[136:139], v[172:175], a[244:247]
    v_mfma_f32_16x16x32_bf16 a[236:239], v[140:143], v[160:163], a[236:239]
    v_mfma_f32_16x16x32_bf16 a[240:243], v[140:143], v[164:167], a[240:243]
    buffer_load_dwordx4 v[212:215], v44, s[16:19], s47 offen offset:0 sc1
    v_mfma_f32_16x16x32_bf16 a[244:247], v[140:143], v[168:171], a[244:247]
    v_mfma_f32_16x16x32_bf16 a[248:251], v[140:143], v[172:175], a[248:251]
    s_waitcnt lgkmcnt(6)
    v_mfma_f32_16x16x32_bf16 a[240:243], v[128:131], v[176:179], a[240:243]
    v_mfma_f32_16x16x32_bf16 a[244:247], v[132:135], v[176:179], a[244:247]
    buffer_load_dwordx4 v[216:219], v43, s[16:19], s47 offen offset:2048 sc1
    v_mfma_f32_16x16x32_bf16 a[248:251], v[136:139], v[176:179], a[248:251]
    v_mfma_f32_16x16x32_bf16 a[252:255], v[140:143], v[176:179], a[252:255]
    v_mfma_f32_16x16x32_bf16 a[240:243], v[144:147], v[160:163], a[240:243]
    v_mfma_f32_16x16x32_bf16 a[244:247], v[144:147], v[164:167], a[244:247]
    buffer_load_dwordx4 v[220:223], v44, s[16:19], s47 offen offset:2048 sc1
    v_mfma_f32_16x16x32_bf16 a[248:251], v[144:147], v[168:171], a[248:251]
    v_mfma_f32_16x16x32_bf16 a[252:255], v[144:147], v[172:175], a[252:255]
    s_waitcnt lgkmcnt(4)
    v_mfma_f32_16x16x32_bf16 a[244:247], v[128:131], v[180:183], a[244:247]
    buffer_load_dwordx4 v[224:227], v43, s[16:19], s48 offen offset:0 sc1
    v_mfma_f32_16x16x32_bf16 a[248:251], v[132:135], v[180:183], a[248:251]
    v_mfma_f32_16x16x32_bf16 a[252:255], v[136:139], v[180:183], a[252:255]
    v_mfma_f32_16x16x32_bf16 a[244:247], v[148:151], v[160:163], a[244:247]
    v_mfma_f32_16x16x32_bf16 a[248:251], v[148:151], v[164:167], a[248:251]
    buffer_load_dwordx4 v[228:231], v44, s[16:19], s48 offen offset:0 sc1
    v_mfma_f32_16x16x32_bf16 a[252:255], v[148:151], v[168:171], a[252:255]
    s_waitcnt lgkmcnt(2)
    v_mfma_f32_16x16x32_bf16 a[248:251], v[128:131], v[184:187], a[248:251]
    v_mfma_f32_16x16x32_bf16 a[252:255], v[132:135], v[184:187], a[252:255]
    v_mfma_f32_16x16x32_bf16 a[248:251], v[152:155], v[160:163], a[248:251]
    buffer_load_dwordx4 v[232:235], v43, s[16:19], s48 offen offset:2048 sc1
    v_mfma_f32_16x16x32_bf16 a[252:255], v[152:155], v[164:167], a[252:255]
    ds_read_b64_tr_b16 a[144:145], v38 offset:49152
    s_waitcnt lgkmcnt(1)
    v_mfma_f32_16x16x32_bf16 a[252:255], v[128:131], v[188:191], a[252:255]
    ds_read_b64_tr_b16 a[146:147], v38 offset:50176
    v_mfma_f32_16x16x32_bf16 a[252:255], v[156:159], v[160:163], a[252:255]
    buffer_load_dwordx4 v[236:239], v44, s[16:19], s48 offen offset:2048 sc1
    ds_read_b64_tr_b16 a[148:149], v39 offset:49152
    s_waitcnt vmcnt(11)
    v_mfma_f32_32x32x16_bf16 v[128:143], a[0:3], v[192:195], 0
    ds_read_b64_tr_b16 a[150:151], v39 offset:50176
    v_mfma_f32_32x32x16_bf16 v[160:175], a[4:7], v[192:195], 0
    buffer_load_dwordx4 v[240:243], v43, s[16:19], s49 offen offset:0 sc1
    ds_read_b64_tr_b16 a[152:153], v38 offset:51200
    s_nop 4
    s_cmp_eq_u32 s99, 0
    s_cbranch_scc1 L_x0
    ds_write_b128 v46, a[224:227] offset:0
    v_accvgpr_read_b32 v4, a240
    v_accvgpr_read_b32 v5, a241
    v_accvgpr_read_b32 v6, a242
    v_accvgpr_read_b32 v7, a243
    s_waitcnt vmcnt(11)
    v_mfma_f32_32x32x16_bf16 v[144:159], a[0:3], v[196:199], 0
    buffer_load_dwordx4 v[244:247], v44, s[16:19], s49 offen offset:0 sc1
    buffer_load_dword v41, v40, s[16:19], 0 offen sc1
    ds_read_b64_tr_b16 a[154:155], v38 offset:52224
    ds_write_b128 v46, a[228:231] offset:1024
    v_accvgpr_read_b32 v8, a244
    v_accvgpr_read_b32 v9, a245
    v_accvgpr_read_b32 v10, a246
    v_accvgpr_read_b32 v11, a247
    v_mfma_f32_32x32x16_bf16 v[176:191], a[4:7], v[196:199], 0
    ds_read_b64_tr_b16 a[156:157], v39 offset:51200
    ds_write_b128 v46, a[232:235] offset:2048
    v_accvgpr_read_b32 v12, a248
    v_accvgpr_read_b32 v13, a249
    v_accvgpr_read_b32 v14, a250
    v_accvgpr_read_b32 v15, a251
    s_waitcnt vmcnt(12)
    v_mfma_f32_32x32x16_bf16 v[128:143], a[8:11], v[200:203], v[128:143]
    buffer_load_dwordx4 v[248:251], v43, s[16:19], s49 offen offset:2048 sc1
    ds_read_b64_tr_b16 a[158:159], v39 offset:52224
    ds_write_b128 v46, a[236:239] offset:3072
    v_accvgpr_read_b32 v16, a252
    v_accvgpr_read_b32 v17, a253
    v_accvgpr_read_b32 v18, a254
    v_accvgpr_read_b32 v19, a255
    s_branch L_x1
L_x0:
    ds_write_b128 v46, a[240:243] offset:0
    v_accvgpr_read_b32 v4, a224
    v_accvgpr_read_b32 v5, a225
    v_accvgpr_read_b32 v6, a226
    v_accvgpr_read_b32 v7, a227
    s_waitcnt vmcnt(11)
    v_mfma_f32_32x32x16_bf16 v[144:159], a[0:3], v[196:199], 0
    buffer_load_dwordx4 v[244:247], v44, s[16:19], s49 offen offset:0 sc1
    buffer_load_dword v41, v40, s[16:19], 0 offen sc1
    ds_read_b64_tr_b16 a[154:155], v38 offset:52224
    ds_write_b128 v46, a[244:247] offset:1024
    v_accvgpr_read_b32 v8, a228
    v_accvgpr_read_b32 v9, a229
    v_accvgpr_read_b32 v10, a230
    v_accvgpr_read_b32 v11, a231
    v_mfma_f32_32x32x16_bf16 v[176:191], a[4:7], v[196:199], 0
    ds_read_b64_tr_b16 a[156:157], v39 offset:51200
    ds_write_b128 v46, a[248:251] offset:2048
    v_accvgpr_read_b32 v12, a232
    v_accvgpr_read_b32 v13, a233
    v_accvgpr_read_b32 v14, a234
    v_accvgpr_read_b32 v15, a235
    s_waitcnt vmcnt(12)
    v_mfma_f32_32x32x16_bf16 v[128:143], a[8:11], v[200:203], v[128:143]
    buffer_load_dwordx4 v[248:251], v43, s[16:19], s49 offen offset:2048 sc1
    ds_read_b64_tr_b16 a[158:159], v39 offset:52224
    ds_write_b128 v46, a[252:255] offset:3072
    v_accvgpr_read_b32 v16, a236
    v_accvgpr_read_b32 v17, a237
    v_accvgpr_read_b32 v18, a238
    v_accvgpr_read_b32 v19, a239
L_x1:
    v_mfma_f32_32x32x16_bf16 v[160:175], a[12:15], v[200:203], v[160:175]
    buffer_load_dwordx4 v[252:255], v44, s[16:19], s49 offen offset:2048 sc1
    s_add_u32 m0, s92, 84992
    s_waitcnt vmcnt(13)
    v_mfma_f32_32x32x16_bf16 v[144:159], a[8:11], v[204:207], v[144:159]
    s_waitcnt lgkmcnt(0)
    s_barrier
    ds_read_b128 v[20:23], v47 offset:0
    ds_read_b128 v[32:35], v47 offset:1024
    buffer_load_dwordx4 v36, s[12:15], s38 offen offset:0 lds
    v_mfma_f32_32x32x16_bf16 v[176:191], a[12:15], v[204:207], v[176:191]
    buffer_load_dwordx4 v37, s[12:15], s38 offen offset:1024 lds
    s_waitcnt vmcnt(14)
    v_mfma_f32_32x32x16_bf16 v[128:143], a[16:19], v[208:211], v[128:143]
    s_waitcnt lgkmcnt(0)
    v_pk_add_f32 v[4:5], v[4:5], v[20:21]
    v_pk_add_f32 v[6:7], v[6:7], v[22:23]
    v_pk_add_f32 v[8:9], v[8:9], v[32:33]
    v_pk_add_f32 v[10:11], v[10:11], v[34:35]
    buffer_load_dwordx4 v28, s[12:15], s38 offen offset:2048 lds
    v_mfma_f32_32x32x16_bf16 v[160:175], a[20:23], v[208:211], v[160:175]
    v_cvt_pk_bf16_f32 v20, v4, v5
    v_cvt_pk_bf16_f32 v22, v8, v9
    v_cvt_pk_bf16_f32 v21, v6, v7
    v_cvt_pk_bf16_f32 v23, v10, v11
    ds_read_b128 v[32:35], v47 offset:2048
    ds_read_b128 v[4:7], v47 offset:3072
    s_waitcnt vmcnt(14)
    v_mfma_f32_32x32x16_bf16 v[144:159], a[16:19], v[212:215], v[144:159]
    v_permlane16_swap_b32 v20, v22
    v_permlane16_swap_b32 v21, v23
    buffer_store_dwordx4 v[20:23], v45, s[16:19], 0 offen offset:0 sc1
    buffer_load_dwordx4 v42, s[12:15], s38 offen offset:3072 lds
    v_mfma_f32_32x32x16_bf16 v[176:191], a[20:23], v[212:215], v[176:191]
    s_waitcnt lgkmcnt(0)
    v_pk_add_f32 v[12:13], v[12:13], v[32:33]
    v_pk_add_f32 v[14:15], v[14:15], v[34:35]
    v_pk_add_f32 v[16:17], v[16:17], v[4:5]
    v_pk_add_f32 v[18:19], v[18:19], v[6:7]
    buffer_load_dwordx4 v[64:67], v43, s[16:19], s50 offen offset:0 sc1
    ds_read_b64_tr_b16 a[160:161], v38 offset:0
    s_waitcnt vmcnt(16)
    v_mfma_f32_32x32x16_bf16 v[128:143], a[24:27], v[216:219], v[128:143]
    v_cvt_pk_bf16_f32 v8, v12, v13
    v_cvt_pk_bf16_f32 v10, v16, v17
    v_cvt_pk_bf16_f32 v9, v14, v15
    v_cvt_pk_bf16_f32 v11, v18, v19
    buffer_load_dwordx4 v[68:71], v44, s[16:19], s50 offen offset:0 sc1
    ds_read_b64_tr_b16 a[162:163], v38 offset:1024
    v_mfma_f32_32x32x16_bf16 v[160:175], a[28:31], v[216:219], v[160:175]
    v_permlane16_swap_b32 v8, v10
    v_permlane16_swap_b32 v9, v11
    buffer_store_dwordx4 v[8:11], v45, s[16:19], 0 offen offset:1024 sc1
    buffer_load_dwordx4 v[72:75], v43, s[16:19], s50 offen offset:2048 sc1
    ds_read_b64_tr_b16 a[164:165], v39 offset:0
    s_waitcnt vmcnt(18)
    v_mfma_f32_32x32x16_bf16 v[144:159], a[24:27], v[220:223], v[144:159]
    buffer_load_dwordx4 v[76:79], v44, s[16:19], s50 offen offset:2048 sc1
    ds_read_b64_tr_b16 a[166:167], v39 offset:1024
    v_mfma_f32_32x32x16_bf16 v[176:191], a[28:31], v[220:223], v[176:191]
    buffer_load_dwordx4 v[80:83], v43, s[16:19], s51 offen offset:0 sc1
    ds_read_b64_tr_b16 a[168:169], v38 offset:2048
    s_waitcnt vmcnt(19)
    v_mfma_f32_32x32x16_bf16 v[128:143], a[32:35], v[224:227], v[128:143]
    ds_read_b64_tr_b16 a[170:171], v38 offset:3072
    v_mfma_f32_32x32x16_bf16 v[160:175], a[36:39], v[224:227], v[160:175]
    buffer_load_dwordx4 v[84:87], v44, s[16:19], s51 offen offset:0 sc1
    ds_read_b64_tr_b16 a[172:173], v39 offset:2048
    s_waitcnt vmcnt(19)
    v_mfma_f32_32x32x16_bf16 v[144:159], a[32:35], v[228:231], v[144:159]
    ds_read_b64_tr_b16 a[174:175], v39 offset:3072
    v_mfma_f32_32x32x16_bf16 v[176:191], a[36:39], v[228:231], v[176:191]
    buffer_load_dwordx4 v[88:91], v43, s[16:19], s51 offen offset:2048 sc1
    ds_read_b64_tr_b16 a[176:177], v38 offset:16384
    s_waitcnt vmcnt(19)
    v_mfma_f32_32x32x16_bf16 v[128:143], a[40:43], v[232:235], v[128:143]
    ds_read_b64_tr_b16 a[178:179], v38 offset:17408
    v_mfma_f32_32x32x16_bf16 v[160:175], a[44:47], v[232:235], v[160:175]
    buffer_load_dwordx4 v[92:95], v44, s[16:19], s51 offen offset:2048 sc1
    ds_read_b64_tr_b16 a[180:181], v39 offset:16384
    s_waitcnt vmcnt(19)
    v_mfma_f32_32x32x16_bf16 v[144:159], a[40:43], v[236:239], v[144:159]
    ds_read_b64_tr_b16 a[182:183], v39 offset:17408
    v_mfma_f32_32x32x16_bf16 v[176:191], a[44:47], v[236:239], v[176:191]
    buffer_load_dwordx4 v[96:99], v43, s[16:19], s52 offen offset:0 sc1
    ds_read_b64_tr_b16 a[184:185], v38 offset:18432
    s_waitcnt vmcnt(19)
    v_mfma_f32_32x32x16_bf16 v[128:143], a[48:51], v[240:243], v[128:143]
    ds_read_b64_tr_b16 a[186:187], v38 offset:19456
    v_mfma_f32_32x32x16_bf16 v[160:175], a[52:55], v[240:243], v[160:175]
    buffer_load_dwordx4 v[100:103], v44, s[16:19], s52 offen offset:0 sc1
    ds_read_b64_tr_b16 a[188:189], v39 offset:18432
    s_waitcnt vmcnt(19)
    v_mfma_f32_32x32x16_bf16 v[144:159], a[48:51], v[244:247], v[144:159]
    ds_read_b64_tr_b16 a[190:191], v39 offset:19456
    v_mfma_f32_32x32x16_bf16 v[176:191], a[52:55], v[244:247], v[176:191]
    buffer_load_dwordx4 v[104:107], v43, s[16:19], s52 offen offset:2048 sc1
    ds_read_b64_tr_b16 a[192:193], v38 offset:32768
    s_waitcnt vmcnt(18)
    v_mfma_f32_32x32x16_bf16 v[128:143], a[56:59], v[248:251], v[128:143]
    ds_read_b64_tr_b16 a[194:195], v38 offset:33792
    s_waitcnt vmcnt(9)
    s_mov_b64 exec, 1
    buffer_store_dword v29, v26, s[16:19], s75 offen offset:0 sc1
    s_mov_b64 exec, -1
    v_mfma_f32_32x32x16_bf16 v[160:175], a[60:63], v[248:251], v[160:175]
    buffer_load_dwordx4 v[108:111], v44, s[16:19], s52 offen offset:2048 sc1
    ds_read_b64_tr_b16 a[196:197], v39 offset:32768
    v_mfma_f32_32x32x16_bf16 v[144:159], a[56:59], v[252:255], v[144:159]
    ds_read_b64_tr_b16 a[198:199], v39 offset:33792
    v_mfma_f32_32x32x16_bf16 v[176:191], a[60:63], v[252:255], v[176:191]
    v_cmp_ne_u32 vcc, s63, v41
    s_nop 1
    s_cbranch_vccnz slow_10
ret_11:
    v_add_u32 v43, 4096, v43
    v_add_u32 v44, 4096, v44
    buffer_load_dwordx4 v[112:115], v43, s[16:19], 0 offen offset:0 sc1
    ds_read_b64_tr_b16 a[200:201], v38 offset:34816
    v_mfma_f32_32x32x16_bf16 v[128:143], a[64:67], v[64:67], v[128:143]
    ds_read_b64_tr_b16 a[202:203], v38 offset:35840
    v_mfma_f32_32x32x16_bf16 v[160:175], a[68:71], v[64:67], v[160:175]
    buffer_load_dwordx4 v[116:119], v44, s[16:19], 0 offen offset:0 sc1
    ds_read_b64_tr_b16 a[204:205], v39 offset:34816
    v_mfma_f32_32x32x16_bf16 v[144:159], a[64:67], v[68:71], v[144:159]
    ds_read_b64_tr_b16 a[206:207], v39 offset:35840
    v_mfma_f32_32x32x16_bf16 v[176:191], a[68:71], v[68:71], v[176:191]
    buffer_load_dwordx4 v[120:123], v43, s[16:19], 0 offen offset:2048 sc1
    s_waitcnt vmcnt(13)
    v_mfma_f32_32x32x16_bf16 v[128:143], a[72:75], v[72:75], v[128:143]
    ds_read_b64_tr_b16 a[208:209], v38 offset:49152
    v_mfma_f32_32x32x16_bf16 v[160:175], a[76:79], v[72:75], v[160:175]
    buffer_load_dwordx4 v[124:127], v44, s[16:19], 0 offen offset:2048 sc1
    ds_read_b64_tr_b16 a[210:211], v38 offset:50176
    s_waitcnt vmcnt(13)
    v_mfma_f32_32x32x16_bf16 v[144:159], a[72:75], v[76:79], v[144:159]
    ds_read_b64_tr_b16 a[212:213], v39 offset:49152
    v_mfma_f32_32x32x16_bf16 v[176:191], a[76:79], v[76:79], v[176:191]
    buffer_load_dwordx4 v[192:195], v43, s[16:19], s47 offen offset:0 sc1
    ds_read_b64_tr_b16 a[214:215], v39 offset:50176
    s_waitcnt vmcnt(13)
    v_mfma_f32_32x32x16_bf16 v[128:143], a[80:83], v[80:83], v[128:143]
    ds_read_b64_tr_b16 a[216:217], v38 offset:51200
    v_mfma_f32_32x32x16_bf16 v[160:175], a[84:87], v[80:83], v[160:175]
    buffer_load_dwordx4 v[196:199], v44, s[16:19], s47 offen offset:0 sc1
    ds_read_b64_tr_b16 a[218:219], v38 offset:52224
    s_waitcnt vmcnt(13)
    v_mfma_f32_32x32x16_bf16 v[144:159], a[80:83], v[84:87], v[144:159]
    ds_read_b64_tr_b16 a[220:221], v39 offset:51200
    v_mfma_f32_32x32x16_bf16 v[176:191], a[84:87], v[84:87], v[176:191]
    buffer_load_dwordx4 v[200:203], v43, s[16:19], s47 offen offset:2048 sc1
    ds_read_b64_tr_b16 a[222:223], v39 offset:52224
    s_waitcnt vmcnt(13)
    v_mfma_f32_32x32x16_bf16 v[128:143], a[88:91], v[88:91], v[128:143]
    v_mfma_f32_32x32x16_bf16 v[160:175], a[92:95], v[88:91], v[160:175]
    buffer_load_dwordx4 v[204:207], v44, s[16:19], s47 offen offset:2048 sc1
    s_waitcnt vmcnt(13)
    v_mfma_f32_32x32x16_bf16 v[144:159], a[88:91], v[92:95], v[144:159]
    v_mfma_f32_32x32x16_bf16 v[176:191], a[92:95], v[92:95], v[176:191]
    s_waitcnt vmcnt(12)
    v_mfma_f32_32x32x16_bf16 v[128:143], a[96:99], v[96:99], v[128:143]
    buffer_load_dwordx4 v[208:211], v43, s[16:19], s48 offen offset:0 sc1
    v_mfma_f32_32x32x16_bf16 v[160:175], a[100:103], v[96:99], v[160:175]
    s_waitcnt vmcnt(12)
    v_mfma_f32_32x32x16_bf16 v[144:159], a[96:99], v[100:103], v[144:159]
    buffer_load_dwordx4 v[212:215], v44, s[16:19], s48 offen offset:0 sc1
    v_mfma_f32_32x32x16_bf16 v[176:191], a[100:103], v[100:103], v[176:191]
    s_waitcnt vmcnt(12)
    v_mfma_f32_32x32x16_bf16 v[128:143], a[104:107], v[104:107], v[128:143]
    buffer_load_dwordx4 v[216:219], v43, s[16:19], s48 offen offset:2048 sc1
    v_mfma_f32_32x32x16_bf16 v[160:175], a[108:111], v[104:107], v[160:175]
    s_waitcnt vmcnt(11)
    v_mfma_f32_32x32x16_bf16 v[144:159], a[104:107], v[108:111], v[144:159]
    buffer_load_dwordx4 v[220:223], v44, s[16:19], s48 offen offset:2048 sc1
    v_mfma_f32_32x32x16_bf16 v[176:191], a[108:111], v[108:111], v[176:191]
    s_waitcnt vmcnt(11)
    v_mfma_f32_32x32x16_bf16 v[128:143], a[112:115], v[112:115], v[128:143]
    buffer_load_dwordx4 v[228:231], v44, s[16:19], s49 offen offset:0 sc1
    v_mfma_f32_32x32x16_bf16 v[160:175], a[116:119], v[112:115], v[160:175]
    s_waitcnt vmcnt(11)
    v_mfma_f32_32x32x16_bf16 v[144:159], a[112:115], v[116:119], v[144:159]
    buffer_load_dwordx4 v[236:239], v44, s[16:19], s49 offen offset:2048 sc1
    v_mfma_f32_32x32x16_bf16 v[176:191], a[116:119], v[116:119], v[176:191]
    s_waitcnt vmcnt(11)
    v_mfma_f32_32x32x16_bf16 v[128:143], a[120:123], v[120:123], v[128:143]
    buffer_load_dwordx4 v[244:247], v44, s[16:19], s50 offen offset:0 sc1
    v_mfma_f32_32x32x16_bf16 v[160:175], a[124:127], v[120:123], v[160:175]
    s_waitcnt vmcnt(11)
    v_mfma_f32_32x32x16_bf16 v[144:159], a[120:123], v[124:127], v[144:159]
    buffer_load_dwordx4 v[252:255], v44, s[16:19], s50 offen offset:2048 sc1
    v_mfma_f32_32x32x16_bf16 v[176:191], a[124:127], v[124:127], v[176:191]
    s_waitcnt vmcnt(11)
    v_mfma_f32_32x32x16_bf16 v[128:143], a[128:131], v[192:195], v[128:143]
    buffer_load_dwordx4 v[68:71], v44, s[16:19], s51 offen offset:0 sc1
    v_mfma_f32_32x32x16_bf16 v[160:175], a[132:135], v[192:195], v[160:175]
    s_waitcnt vmcnt(11)
    v_mfma_f32_32x32x16_bf16 v[144:159], a[128:131], v[196:199], v[144:159]
    buffer_load_dwordx4 v[76:79], v44, s[16:19], s51 offen offset:2048 sc1
    v_mfma_f32_32x32x16_bf16 v[176:191], a[132:135], v[196:199], v[176:191]
    s_waitcnt vmcnt(11)
    v_mfma_f32_32x32x16_bf16 v[128:143], a[136:139], v[200:203], v[128:143]
    buffer_load_dwordx4 v[84:87], v44, s[16:19], s52 offen offset:0 sc1
    v_mfma_f32_32x32x16_bf16 v[160:175], a[140:143], v[200:203], v[160:175]
    s_waitcnt vmcnt(11)
    v_mfma_f32_32x32x16_bf16 v[144:159], a[136:139], v[204:207], v[144:159]
    buffer_load_dwordx4 v[92:95], v44, s[16:19], s52 offen offset:2048 sc1
    v_mfma_f32_32x32x16_bf16 v[176:191], a[140:143], v[204:207], v[176:191]
    s_waitcnt vmcnt(11)
    v_mfma_f32_32x32x16_bf16 v[128:143], a[144:147], v[208:211], v[128:143]
    buffer_load_dwordx4 v[224:227], v43, s[16:19], s49 offen offset:0 sc1
    v_mfma_f32_32x32x16_bf16 v[160:175], a[148:151], v[208:211], v[160:175]
    s_waitcnt vmcnt(11)
    v_mfma_f32_32x32x16_bf16 v[144:159], a[144:147], v[212:215], v[144:159]
    buffer_load_dwordx4 v[232:235], v43, s[16:19], s49 offen offset:2048 sc1
    v_mfma_f32_32x32x16_bf16 v[176:191], a[148:151], v[212:215], v[176:191]
    s_waitcnt vmcnt(11)
    v_mfma_f32_32x32x16_bf16 v[128:143], a[152:155], v[216:219], v[128:143]
    buffer_load_dwordx4 v[240:243], v43, s[16:19], s50 offen offset:0 sc1
    v_mfma_f32_32x32x16_bf16 v[160:175], a[156:159], v[216:219], v[160:175]
    s_waitcnt vmcnt(11)
    v_mfma_f32_32x32x16_bf16 v[144:159], a[152:155], v[220:223], v[144:159]
    buffer_load_dwordx4 v[248:251], v43, s[16:19], s50 offen offset:2048 sc1
    v_mfma_f32_32x32x16_bf16 v[176:191], a[156:159], v[220:223], v[176:191]
    s_waitcnt vmcnt(11) lgkmcnt(15)
    v_mfma_f32_32x32x16_bf16 v[176:191], a[164:167], v[228:231], v[176:191]
    buffer_load_dwordx4 v[64:67], v43, s[16:19], s51 offen offset:0 sc1
    v_mfma_f32_32x32x16_bf16 v[144:159], a[160:163], v[228:231], v[144:159]
    s_waitcnt vmcnt(11)
    v_mfma_f32_32x32x16_bf16 v[176:191], a[172:175], v[236:239], v[176:191]
    v_mfma_f32_32x32x16_bf16 v[144:159], a[168:171], v[236:239], v[144:159]
    buffer_load_dwordx4 v[72:75], v43, s[16:19], s51 offen offset:2048 sc1
    s_waitcnt vmcnt(11)
    v_mfma_f32_32x32x16_bf16 v[176:191], a[180:183], v[244:247], v[176:191]
    v_mfma_f32_32x32x16_bf16 v[144:159], a[176:179], v[244:247], v[144:159]
    buffer_load_dwordx4 v[80:83], v43, s[16:19], s52 offen offset:0 sc1
    s_waitcnt vmcnt(11)
    v_mfma_f32_32x32x16_bf16 v[176:191], a[188:191], v[252:255], v[176:191]
    buffer_load_dword v63, v59, s[16:19], 0 offen sc1
    v_mfma_f32_32x32x16_bf16 v[144:159], a[184:187], v[252:255], v[144:159]
    buffer_load_dwordx4 v[88:91], v43, s[16:19], s52 offen offset:2048 sc1
    s_waitcnt vmcnt(12) lgkmcnt(8)
    v_mfma_f32_32x32x16_bf16 v[176:191], a[196:199], v[68:71], v[176:191]
    v_mfma_f32_32x32x16_bf16 v[144:159], a[192:195], v[68:71], v[144:159]
    s_waitcnt vmcnt(11)
    v_mfma_f32_32x32x16_bf16 v[176:191], a[204:207], v[76:79], v[176:191]
    v_mfma_f32_32x32x16_bf16 v[144:159], a[200:203], v[76:79], v[144:159]
    s_waitcnt vmcnt(10) lgkmcnt(0)
    v_mfma_f32_32x32x16_bf16 v[176:191], a[212:215], v[84:87], v[176:191]
    s_waitcnt vmcnt(9)
    v_mfma_f32_32x32x16_bf16 v[176:191], a[220:223], v[92:95], v[176:191]
    v_mfma_f32_32x32x16_bf16 v[144:159], a[208:211], v[84:87], v[144:159]
    v_mfma_f32_32x32x16_bf16 v[144:159], a[216:219], v[92:95], v[144:159]
    s_nop 9
    ds_write_b128 v54, v[176:179] offset:0
    s_waitcnt vmcnt(8)
    v_mfma_f32_32x32x16_bf16 v[160:175], a[164:167], v[224:227], v[160:175]
    ds_write_b128 v54, v[180:183] offset:1024
    v_mfma_f32_32x32x16_bf16 v[128:143], a[160:163], v[224:227], v[128:143]
    ds_write_b128 v54, v[184:187] offset:2048
    s_waitcnt vmcnt(7)
    v_mfma_f32_32x32x16_bf16 v[160:175], a[172:175], v[232:235], v[160:175]
    ds_write_b128 v54, v[188:191] offset:3072
    v_mfma_f32_32x32x16_bf16 v[128:143], a[168:171], v[232:235], v[128:143]
    s_waitcnt vmcnt(6)
    v_mfma_f32_32x32x16_bf16 v[160:175], a[180:183], v[240:243], v[160:175]
    ds_write_b128 v52, v[144:147] offset:0
    s_waitcnt vmcnt(5)
    v_mfma_f32_32x32x16_bf16 v[160:175], a[188:191], v[248:251], v[160:175]
    ds_write_b128 v52, v[148:151] offset:1024
    s_waitcnt vmcnt(4)
    v_mfma_f32_32x32x16_bf16 v[160:175], a[196:199], v[64:67], v[160:175]
    s_waitcnt vmcnt(1)
    v_cmp_ne_u32 vcc, s63, v63
    s_nop 1
    s_cbranch_vccnz slow_13
ret_14:
    s_mov_b32 m0, s95
    s_nop 0
    buffer_load_dwordx4 v48, s[16:19], 0 offen sc1 lds
    buffer_load_dwordx4 v49, s[16:19], 0 offen offset:1024 sc1 lds
    buffer_load_dword v30, v50, s[16:19], 0 offen sc1
    ds_write_b128 v52, v[152:155] offset:2048
    v_mfma_f32_32x32x16_bf16 v[160:175], a[204:207], v[72:75], v[160:175]
    v_mfma_f32_32x32x16_bf16 v[160:175], a[212:215], v[80:83], v[160:175]
    ds_write_b128 v52, v[156:159] offset:3072
    s_waitcnt vmcnt(3)
    v_mfma_f32_32x32x16_bf16 v[160:175], a[220:223], v[88:91], v[160:175]
    v_mfma_f32_32x32x16_bf16 v[128:143], a[176:179], v[240:243], v[128:143]
    v_mfma_f32_32x32x16_bf16 v[128:143], a[184:187], v[248:251], v[128:143]
    s_nop 9
    ds_write_b128 v53, v[160:163] offset:0
    v_mfma_f32_32x32x16_bf16 v[128:143], a[192:195], v[64:67], v[128:143]
    ds_write_b128 v53, v[164:167] offset:1024
    v_mfma_f32_32x32x16_bf16 v[128:143], a[200:203], v[72:75], v[128:143]
    ds_write_b128 v53, v[168:171] offset:2048
    v_mfma_f32_32x32x16_bf16 v[128:143], a[208:211], v[80:83], v[128:143]
    ds_write_b128 v53, v[172:175] offset:3072
    v_mfma_f32_32x32x16_bf16 v[128:143], a[216:219], v[88:91], v[128:143]
    s_waitcnt lgkmcnt(0)
    s_barrier
    ds_read_b128 v[64:67], v55 offset:0
    ds_read_b128 v[68:71], v55 offset:1024
    ds_read_b128 v[72:75], v55 offset:2048
    ds_read_b128 v[76:79], v55 offset:3072
    ds_read_b128 v[80:83], v55 offset:4096
    ds_read_b128 v[84:87], v55 offset:5120
    ds_read_b128 v[88:91], v55 offset:6144
    ds_read_b128 v[92:95], v55 offset:7168
    ds_read_b128 v[96:99], v55 offset:8192
    ds_read_b128 v[100:103], v55 offset:9216
    ds_read_b128 v[104:107], v55 offset:10240
    ds_read_b128 v[108:111], v55 offset:11264
    s_waitcnt lgkmcnt(8)
    v_pk_add_f32 v[128:129], v[128:129], v[64:65]
    v_pk_add_f32 v[130:131], v[130:131], v[66:67]
    v_pk_add_f32 v[132:133], v[132:133], v[68:69]
    v_pk_add_f32 v[134:135], v[134:135], v[70:71]
    v_pk_add_f32 v[136:137], v[136:137], v[72:73]
    v_pk_add_f32 v[138:139], v[138:139], v[74:75]
    v_pk_add_f32 v[140:141], v[140:141], v[76:77]
    v_pk_add_f32 v[142:143], v[142:143], v[78:79]
    s_waitcnt lgkmcnt(4)
    v_pk_add_f32 v[128:129], v[128:129], v[80:81]
    v_pk_add_f32 v[130:131], v[130:131], v[82:83]
    v_pk_add_f32 v[132:133], v[132:133], v[84:85]
    v_pk_add_f32 v[134:135], v[134:135], v[86:87]
    v_pk_add_f32 v[136:137], v[136:137], v[88:89]
    v_pk_add_f32 v[138:139], v[138:139], v[90:91]
    v_pk_add_f32 v[140:141], v[140:141], v[92:93]
    v_pk_add_f32 v[142:143], v[142:143], v[94:95]
    s_waitcnt lgkmcnt(0)
    s_waitcnt vmcnt(0)
    s_barrier
    ds_read_b64_tr_b16 v[112:113], v56 offset:0
    ds_read_b64_tr_b16 v[114:115], v56 offset:1024
    ds_read_b64_tr_b16 v[116:117], v56 offset:2048
    ds_read_b64_tr_b16 v[118:119], v56 offset:3072
    v_pk_add_f32 v[128:129], v[128:129], v[96:97]
    v_pk_add_f32 v[130:131], v[130:131], v[98:99]
    v_pk_add_f32 v[132:133], v[132:133], v[100:101]
    v_pk_add_f32 v[134:135], v[134:135], v[102:103]
    v_pk_add_f32 v[136:137], v[136:137], v[104:105]
    v_pk_add_f32 v[138:139], v[138:139], v[106:107]
    v_pk_add_f32 v[140:141], v[140:141], v[108:109]
    v_pk_add_f32 v[142:143], v[142:143], v[110:111]
    s_waitcnt lgkmcnt(0)
    v_lshlrev_b32 v192, 16, v112
    v_and_b32 v193, 0xffff0000, v112
    v_lshlrev_b32 v194, 16, v113
    v_and_b32 v195, 0xffff0000, v113
    v_lshlrev_b32 v196, 16, v114
    v_and_b32 v197, 0xffff0000, v114
    v_lshlrev_b32 v198, 16, v115
    v_and_b32 v199, 0xffff0000, v115
    v_lshlrev_b32 v200, 16, v116
    v_and_b32 v201, 0xffff0000, v116
    v_lshlrev_b32 v202, 16, v117
    v_and_b32 v203, 0xffff0000, v117
    v_lshlrev_b32 v204, 16, v118
    v_and_b32 v205, 0xffff0000, v118
    v_lshlrev_b32 v206, 16, v119
    v_and_b32 v207, 0xffff0000, v119
    v_pk_add_f32 v[192:193], v[192:193], v[128:129] neg_lo:[0,1] neg_hi:[0,1]
    v_pk_fma_f32 v[192:193], v[192:193], v[30:31], v[128:129] op_sel_hi:[1,0,1]
    v_cvt_pk_bf16_f32 v120, v192, v193
    v_pk_add_f32 v[194:195], v[194:195], v[130:131] neg_lo:[0,1] neg_hi:[0,1]
    v_pk_fma_f32 v[194:195], v[194:195], v[30:31], v[130:131] op_sel_hi:[1,0,1]
    v_cvt_pk_bf16_f32 v121, v194, v195
    v_pk_add_f32 v[196:197], v[196:197], v[132:133] neg_lo:[0,1] neg_hi:[0,1]
    v_pk_fma_f32 v[196:197], v[196:197], v[30:31], v[132:133] op_sel_hi:[1,0,1]
    v_cvt_pk_bf16_f32 v122, v196, v197
    v_pk_add_f32 v[198:199], v[198:199], v[134:135] neg_lo:[0,1] neg_hi:[0,1]
    v_pk_fma_f32 v[198:199], v[198:199], v[30:31], v[134:135] op_sel_hi:[1,0,1]
    v_cvt_pk_bf16_f32 v123, v198, v199
    v_permlane32_swap_b32 v120, v122
    s_nop 0
    v_permlane32_swap_b32 v121, v123
    buffer_store_dwordx4 v[120:123], v51, s[20:23], 0 offen offset:0
    v_pk_add_f32 v[200:201], v[200:201], v[136:137] neg_lo:[0,1] neg_hi:[0,1]
    v_pk_fma_f32 v[200:201], v[200:201], v[30:31], v[136:137] op_sel_hi:[1,0,1]
    v_cvt_pk_bf16_f32 v124, v200, v201
    v_pk_add_f32 v[202:203], v[202:203], v[138:139] neg_lo:[0,1] neg_hi:[0,1]
    v_pk_fma_f32 v[202:203], v[202:203], v[30:31], v[138:139] op_sel_hi:[1,0,1]
    v_cvt_pk_bf16_f32 v125, v202, v203
    v_pk_add_f32 v[204:205], v[204:205], v[140:141] neg_lo:[0,1] neg_hi:[0,1]
    v_pk_fma_f32 v[204:205], v[204:205], v[30:31], v[140:141] op_sel_hi:[1,0,1]
    v_cvt_pk_bf16_f32 v126, v204, v205
    v_pk_add_f32 v[206:207], v[206:207], v[142:143] neg_lo:[0,1] neg_hi:[0,1]
    v_pk_fma_f32 v[206:207], v[206:207], v[30:31], v[142:143] op_sel_hi:[1,0,1]
    v_cvt_pk_bf16_f32 v127, v206, v207
    v_permlane32_swap_b32 v124, v126
    s_nop 0
    v_permlane32_swap_b32 v125, v127
    buffer_store_dwordx4 v[124:127], v51, s[20:23], 0 offen offset:32
    s_endpgm
L_hpro:
    s_mov_b32 s65, 3
    s_lshl_b32 s30, s60, 2
    v_xor_b32 v68, s30, v1
    v_lshlrev_b32 v3, 4, v68
    v_xor_b32 v4, 32, v3
    s_lshl_b32 s31, s64, 16
    s_lshl_b32 s3, s60, 14
    s_add_u32 s31, s31, s3
    v_and_b32 v5, 7, v1
    v_lshrrev_b32 v6, 3, v1
    s_lshl_b32 s30, s60, 4
    v_add_u32 v6, s30, v6
    v_lshlrev_b32 v7, 4, v6
    s_lshl_b32 s30, s2, 2
    s_waitcnt lgkmcnt(0)
    global_load_short_d16_hi v64, v72, s[34:35]
    global_load_short_d16_hi v65, v72, s[36:37]
    global_load_short_d16_hi v66, v72, s[38:39]
    global_load_short_d16_hi v67, v72, s[40:41]
    s_load_dword s72, s[42:43], s30
    s_load_dword s73, s[44:45], s30
    s_load_dword s63, s[18:19], 8192
    s_mov_b64 s[4:5], s[32:33]
    s_mov_b64 s[50:51], s[10:11]
    s_mov_b32 s10, 0x1c0000
    s_mov_b32 s11, 0x20000
    global_load_dwordx4 v[232:235], v7, s[12:13]
    global_load_dwordx4 v[236:239], v7, s[12:13] offset:128
    s_mov_b32 s84, s31
    s_mov_b32 s85, s3
    s_lshl_b32 s30, s64, 2
    s_add_u32 s30, s30, s60
    s_mul_i32 s30, s30, 56
    v_min_u32 v13, 55, v1
    v_add_u32 v13, s30, v13
    v_lshrrev_b32 v12, 8, v13
    v_lshlrev_b32 v12, 15, v12
    v_lshl_add_u32 v13, v13, 7, v12
    s_add_u32 m0, s85, 0
    s_add_u32 s86, s84, 0
    buffer_load_dwordx4 v3, s[4:7], s86 offen offset:0 lds
    s_add_u32 m0, s85, 0
    s_add_u32 s86, s84, 0
    buffer_load_dwordx4 v3, s[4:7], s86 offen offset:1024 lds
    s_add_u32 m0, s85, 0
    s_add_u32 s86, s84, 0
    buffer_load_dwordx4 v3, s[4:7], s86 offen offset:2048 lds
    s_add_u32 m0, s85, 0
    s_add_u32 s86, s84, 0
    buffer_load_dwordx4 v3, s[4:7], s86 offen offset:3072 lds
    s_add_u32 m0, s85, 4096
    s_add_u32 s86, s84, 4096
    buffer_load_dwordx4 v3, s[4:7], s86 offen offset:0 lds
    s_add_u32 m0, s85, 4096
    s_add_u32 s86, s84, 4096
    buffer_load_dwordx4 v3, s[4:7], s86 offen offset:1024 lds
    s_add_u32 m0, s85, 4096
    s_add_u32 s86, s84, 4096
    buffer_load_dwordx4 v3, s[4:7], s86 offen offset:2048 lds
    s_add_u32 m0, s85, 4096
    s_add_u32 s86, s84, 4096
    buffer_load_dwordx4 v3, s[4:7], s86 offen offset:3072 lds
    s_add_u32 m0, s85, 8192
    s_add_u32 s86, s84, 8192
    buffer_load_dwordx4 v4, s[4:7], s86 offen offset:0 lds
    s_mov_b64 s[20:21], s[14:15]
    s_mov_b64 s[24:25], s[16:17]
    s_mov_b64 s[16:17], s[18:19]
    s_mov_b64 s[12:13], s[50:51]
    s_mov_b32 s14, 0x1c0000
    s_mov_b32 s15, 0x20000
    s_mov_b32 s18, 16777216
    s_mov_b32 s19, 0x20000
    s_mov_b32 s22, 0x200000
    s_mov_b32 s23, 0x20000
    s_mov_b32 s26, 256
    s_mov_b32 s27, 0x20000
    v_lshlrev_b32 v8, 1, v5
    v_xor_b32 v8, v8, v6
    v_lshlrev_b32 v8, 4, v8
    v_lshl_add_u32 v8, v5, 13, v8
    v_xor_b32 v9, 128, v8
    s_lshl_b32 s31, s64, 7
    s_add_u32 s30, s31, 65536
    v_lshlrev_b32 v10, 15, v6
    v_lshl_add_u32 v10, v5, 4, v10
    v_add_u32 v10, s30, v10
    v_add_u32 v11, 262144, v10
    s_add_u32 s74, s31, 24576
    v_mov_b32 v62, 16777216
    v_lshlrev_b32 v12, 7, v1
    s_mov_b32 s87, 32768
    s_and_b32 s30, s62, 3
    s_lshl_b32 s30, s30, 13
    s_mul_i32 s88, s60, 458752
    s_add_u32 s88, s88, s30
    s_mov_b32 s76, 0
    s_mov_b32 s77, 4096
    s_mov_b32 s78, 8192
    s_mov_b32 s79, 12288
    s_mov_b32 s80, 16384
    s_mov_b32 s81, 20480
    s_mov_b32 s82, 24576
    s_mov_b32 s83, 28672
    s_lshr_b32 s98, s60, 1
    s_and_b32 s99, s60, 1
    s_mul_i32 s96, s98, 31232
    s_add_u32 s96, s96, 101376
    v_and_b32 v73, 127, v0
    v_lshrrev_b32 v74, 2, v73
    v_mul_u32_u24 v74, 976, v74
    v_and_b32 v73, 3, v73
    v_lshl_add_u32 v73, v73, 2, v74
    v_add_u32 v73, s96, v73
    v_and_b32 v76, 31, v1
    v_lshrrev_b32 v77, 5, v1
    v_mul_u32_u24 v74, 976, v77
    v_add_u32 v74, s96, v74
    v_add_u32 v75, 32, v76
    v_lshlrev_b32 v78, 2, v76
    v_subrev_u32 v78, 101, v78
    v_cmp_lt_u32 vcc, 27, v76
    s_nop 1
    v_cndmask_b32 v75, v75, v78, vcc
    v_lshl_add_u32 v227, v75, 4, v74
    v_lshl_add_u32 v226, v76, 4, v74
    s_mul_i32 s30, s60, 4224
    s_add_u32 s30, s30, 131072
    v_sub_u32 v224, s30, v2
    v_lshlrev_b32 v79, 9, v77
    v_sub_u32 v225, v224, v79
    v_or_b32 v229, s99, v1
    s_sub_u32 s66, 0, s99
    s_mov_b32 s67, s66
    s_or_b32 s68, s66, 0xaaaaaaaa
    s_mov_b32 s69, s68
    s_and_b32 s70, s66, 0xaaaaaaaa
    s_mov_b32 s71, s70
    v_mov_b32 v240, 0
    v_mov_b32 v241, 0
    v_mov_b32 v242, 0
    v_mov_b32 v243, 0
    v_and_b32 v244, 31, v1
    v_lshrrev_b32 v245, 5, v1
    v_and_b32 v246, 15, v1
    v_lshrrev_b32 v247, 4, v1
    v_bfe_u32 v248, v1, 4, 1
    v_bfe_u32 v249, v1, 2, 2
    v_and_b32 v250, 3, v1
    v_lshrrev_b32 v251, 3, v1
    v_lshlrev_b32 v252, 2, v248
    v_and_b32 v253, 7, v1
    v_xor_b32 v252, v252, v253
    v_lshlrev_b32 v252, 4, v252
    v_lshl_add_u32 v253, v251, 10, v252
    s_mul_i32 s28, s60, 458752
    s_lshl_b32 s29, s65, 7
    s_add_u32 s28, s28, s29
    v_add_u32 v36, s28, v253
    v_add_u32 v37, 7168, v36
    v_add_u32 v28, 14336, v36
    v_add_u32 v42, 21504, v36
    s_mov_b32 s33, 65536
    v_lshl_add_u32 v253, v251, 12, v252
    s_lshl_b32 s28, s65, 2
    s_add_u32 s28, s28, s60
    s_lshl_b32 s28, s28, 16
    s_lshl_b32 s29, s64, 7
    s_add_u32 s28, s28, s29
    s_add_u32 s28, s28, 2162688
    v_add_u32 v48, s28, v253
    v_add_u32 v49, 31744, v48
    s_lshl_b32 s28, s60, 11
    s_add_u32 s95, s28, 143360
    v_lshl_add_u32 v251, v245, 2, v249
    v_lshlrev_b32 v251, 7, v251
    v_bfe_u32 v252, v1, 1, 1
    v_lshl_add_u32 v252, v248, 1, v252
    v_bfe_u32 v253, v1, 3, 1
    v_lshl_add_u32 v252, v253, 2, v252
    v_lshl_add_u32 v252, v252, 4, v251
    v_and_b32 v254, 1, v1
    v_lshl_add_u32 v252, v254, 3, v252
    s_lshl_b32 s28, s98, 6
    v_xor_b32 v252, s28, v252
    s_add_u32 s28, s92, 35840
    v_add_u32 v38, s28, v252
    v_xor_b32 v39, 64, v38
    v_lshl_add_u32 v251, v250, 4, v251
    v_lshl_add_u32 v251, v248, 3, v251
    v_xor_b32 v253, s99, v253
    v_lshl_add_u32 v251, v253, 6, v251
    s_lshl_b32 s29, s98, 12
    s_add_u32 s29, s29, 143360
    v_add_u32 v56, s29, v251
    v_lshrrev_b32 v251, 1, v246
    v_sub_u32 v251, v247, v251
    v_lshlrev_b32 v251, 4, v251
    v_mul_u32_u24 v252, 4224, v254
    s_mul_i32 s30, s98, 8448
    s_lshl_b32 s28, s99, 8
    s_add_u32 s30, s30, s28
    s_add_u32 s30, s30, 131184
    v_add3_u32 v23, v251, v252, s30
    v_and_b32 v251, 1, v249
    v_lshlrev_b32 v251, 1, v251
    v_xor_b32 v251, v251, v247
    v_lshl_add_u32 v251, v249, 3, v251
    v_lshl_add_u32 v251, v251, 2, v250
    s_mul_i32 s3, s98, 17920
    s_lshl_b32 s28, s99, 10
    s_add_u32 s29, s3, s28
    v_lshl_add_u32 v24, v251, 4, s29
    v_xor_b32 v25, 128, v24
    s_mul_i32 s29, s99, 768
    s_add_u32 s29, s29, s3
    v_min_u32 v251, 47, v1
    v_lshl_add_u32 v60, v251, 4, s29
    v_min_u32 v251, 2, v249
    v_sub_u32 v252, 2, v251
    v_min_u32 v252, v252, v250
    v_lshl_add_u32 v252, v251, 2, v252
    v_lshl_add_u32 v61, v252, 2, s3
    s_lshl_b32 s28, s99, 13
    s_add_u32 s93, s28, s3
    s_add_u32 s93, s93, 1536
    s_lshl_b32 s96, s2, 1
    s_add_u32 s96, s96, s98
    s_lshl_b32 s97, s96, 12
    s_lshl_b32 s28, s99, 11
    s_add_u32 s97, s97, s28
    s_add_u32 s28, s97, 65524
    v_lshrrev_b32 v251, 2, v1
    v_xor_b32 v252, 1, v245
    v_lshlrev_b32 v252, 1, v252
    v_xor_b32 v251, v251, v252
    v_lshlrev_b32 v252, 2, v250
    v_lshl_add_u32 v251, v251, 4, v252
    v_add_u32 v32, s28, v251
    v_subrev_u32 v33, 768, v32
    v_subrev_u32 v34, 1536, v32
    v_subrev_u32 v35, 2304, v32
    v_lshl_add_u32 v251, v248, 2, v249
    v_lshl_add_u32 v251, v251, 1, v245
    v_lshl_add_u32 v251, v251, 2, v250
    s_add_u32 s28, s97, 2162688
    v_lshl_add_u32 v45, v251, 4, s28
    s_lshr_b32 s28, s96, 6
    s_lshl_b32 s28, s28, 1
    s_add_u32 s28, s28, s99
    s_lshl_b32 s28, s28, 8
    s_and_b32 s29, s96, 63
    s_lshl_b32 s29, s29, 2
    s_add_u32 s28, s28, s29
    s_add_u32 s75, s28, 8192
    s_add_u32 s28, s92, 102400
    v_add_u32 v46, s28, v2
    s_xor_b32 s28, s92, 4096
    s_add_u32 s28, s28, 102400
    v_add_u32 v47, s28, v2
    s_mul_i32 s30, s64, 112
    s_mul_i32 s28, s60, 28
    s_add_u32 s30, s30, s28
    s_lshl_b32 s30, s30, 1
    s_add_u32 s30, s30, s99
    s_lshl_b32 s30, s30, 10
    s_add_u32 s30, s30, 5242880
    v_add_u32 v43, s30, v2
    v_xor_b32 v44, 1024, v43
    v_and_b32 v251, 17, v1
    v_bfe_u32 v252, v1, 1, 1
    v_lshl_add_u32 v251, v252, 3, v251
    v_lshl_add_u32 v251, v249, 1, v251
    s_lshl_b32 s29, s99, 5
    s_lshl_b32 s28, s64, 6
    s_add_u32 s29, s29, s28
    v_add_u32 v251, s29, v251
    v_lshlrev_b32 v50, 2, v251
    v_add_u32 v50, 16384, v50
    s_lshl_b32 s28, s98, 6
    s_lshl_b32 s29, s65, 7
    s_add_u32 s28, s28, s29
    v_lshl_add_u32 v252, v245, 4, s28
    v_lshl_add_u32 v51, v251, 10, v252
    s_lshr_b32 s30, s2, 6
    s_lshl_b32 s30, s30, 3
    s_add_u32 s30, s30, s61
    s_lshl_b32 s30, s30, 7
    v_lshl_add_u32 v57, v244, 2, s30
    s_lshl_b32 s30, s64, 2
    s_add_u32 s30, s30, s60
    s_lshl_b32 s30, s30, 8
    s_add_u32 s30, s30, 32768
    v_min_u32 v251, 6, v1
    v_lshl_add_u32 v58, v251, 2, s30
    s_add_u32 s30, s30, 128
    v_min_u32 v251, 7, v1
    v_lshl_add_u32 v40, v251, 2, s30
    s_lshr_b32 s28, s64, 4
    s_lshl_b32 s30, s65, 1
    s_add_u32 s30, s30, s28
    s_lshl_b32 s30, s30, 8
    s_add_u32 s30, s30, 8192
    s_lshl_b32 s28, s60, 6
    s_add_u32 s30, s30, s28
    v_lshl_add_u32 v59, v246, 2, s30
    s_xor_b32 s28, s60, 0
    s_mul_i32 s29, s28, 12288
    s_lshr_b32 s28, s28, 1
    s_mul_i32 s28, s28, 94208
    s_add_u32 s29, s29, s28
    v_add_u32 v55, s29, v2
    s_xor_b32 s28, s60, 1
    s_mul_i32 s29, s28, 12288
    s_lshr_b32 s28, s28, 1
    s_mul_i32 s28, s28, 94208
    s_add_u32 s29, s29, s28
    s_add_u32 s29, s29, 0
    v_add_u32 v52, s29, v2
    s_xor_b32 s28, s60, 2
    s_mul_i32 s29, s28, 12288
    s_lshr_b32 s28, s28, 1
    s_mul_i32 s28, s28, 94208
    s_add_u32 s29, s29, s28
    s_add_u32 s29, s29, 4096
    v_add_u32 v53, s29, v2
    s_xor_b32 s28, s60, 3
    s_mul_i32 s29, s28, 12288
    s_lshr_b32 s28, s28, 1
    s_mul_i32 s28, s28, 94208
    s_add_u32 s29, s29, s28
    s_add_u32 s29, s29, 8192
    v_add_u32 v54, s29, v2
    s_mov_b32 s34, 131072
    s_mov_b32 s35, 196608
    s_mov_b32 s36, 262144
    s_mov_b32 s37, 327680
    s_mov_b32 s38, 393216
    s_mov_b32 s47, 8192
    s_mov_b32 s48, 16384
    s_mov_b32 s49, 24576
    s_mov_b32 s50, 32768
    s_mov_b32 s51, 40960
    s_mov_b32 s52, 49152
    s_waitcnt lgkmcnt(0)
    s_lshl_b32 s31, s72, 16
    s_and_b32 s3, s72, 0xffff0000
    s_cmp_eq_u32 s98, 0
    s_cselect_b32 s72, s31, s3
    s_lshl_b32 s31, s73, 16
    s_and_b32 s3, s73, 0xffff0000
    s_cmp_eq_u32 s98, 0
    s_cselect_b32 s73, s31, s3
    s_mov_b32 s31, 0x3fb8aa3b
    s_mov_b32 s3, 0x32a57060
    v_mov_b32 v68, s72
    v_mul_f32 v69, s31, v68
    v_fma_f32 v70, v68, s31, -v69
    v_fmac_f32 v70, s3, v68
    v_exp_f32 v69, v69
    v_mul_f32 v70, 0x3f317218, v70
    v_fma_f32 v68, v69, v70, v69
    v_mov_b32 v228, s73
    v_cmp_eq_u32 vcc, 0, v1
    s_nop 1
    v_cndmask_b32 v228, 0, v228, vcc
    s_waitcnt vmcnt(11)
    v_mul_f32 v69, s31, v64
    v_fma_f32 v70, v64, s31, -v69
    v_fmac_f32 v70, s3, v64
    v_exp_f32 v69, v69
    v_mul_f32 v70, 0x3f317218, v70
    v_fma_f32 v69, v69, v70, v69
    v_cvt_pk_bf16_f32 v68, v68, v69
    v_and_b32 v69, 0xffff0000, v68
    v_lshlrev_b32 v68, 16, v68
    v_mul_f32 v69, v69, v68
    v_mul_f32 v65, v65, v68
    v_mul_f32 v69, s31, v69
    v_mul_f32 v65, 0.15915494, v65
    v_add_f32 v68, v68, v68
    v_pk_mul_f32 v[66:67], v[66:67], v[68:69] op_sel_hi:[1,0]
    v_mul_f32 v96, 0xc1000000, v69
    v_mul_f32 v97, 0x41000000, v65
    v_exp_f32 v96, v96
    v_fract_f32 v97, v97
    v_cos_f32 v82, v97
    v_sin_f32 v83, v97
    v_mul_f32 v98, 0xbf800000, v69
    v_mul_f32 v99, 0x3f800000, v65
    v_exp_f32 v98, v98
    v_fract_f32 v99, v99
    v_cos_f32 v80, v99
    v_sin_f32 v81, v99
    v_mul_f32 v100, 0xc3800000, v69
    v_mul_f32 v101, 0x43800000, v65
    v_exp_f32 v100, v100
    v_fract_f32 v101, v101
    v_cos_f32 v84, v101
    v_sin_f32 v85, v101
    v_pk_mul_f32 v[82:83], v[82:83], v[96:97] op_sel_hi:[1,0]
    v_pk_mul_f32 v[80:81], v[80:81], v[98:99] op_sel_hi:[1,0]
    v_pk_mul_f32 v[84:85], v[84:85], v[100:101] op_sel_hi:[1,0]
    v_mov_b32 v120, 0x3f80
    v_pk_mul_f32 v[122:123], v[82:83], v[82:83] op_sel:[0,0] op_sel_hi:[1,0]
    v_cvt_pk_bf16_f32 v104, v66, -v67
    v_pk_mul_f32 v[86:87], v[80:81], v[80:81] op_sel:[0,0] op_sel_hi:[1,0]
    v_pk_fma_f32 v[122:123], v[82:83], v[82:83], v[122:123] op_sel:[1,1,0] op_sel_hi:[0,1,1] neg_lo:[0,1,0]
    v_cvt_pk_bf16_f32 v105, v82, v83
    ds_write2_b32 v73, v120, v104 offset0:128 offset1:0
    v_pk_fma_f32 v[86:87], v[80:81], v[80:81], v[86:87] op_sel:[1,1,0] op_sel_hi:[0,1,1] neg_lo:[0,1,0]
    v_pk_mul_f32 v[124:125], v[122:123], v[82:83] op_sel:[0,0] op_sel_hi:[1,0]
    v_pk_mul_f32 v[90:91], v[66:67], v[80:81] op_sel:[0,0] op_sel_hi:[1,0]
    v_pk_fma_f32 v[124:125], v[122:123], v[82:83], v[124:125] op_sel:[1,1,0] op_sel_hi:[0,1,1] neg_lo:[0,1,0]
    v_cvt_pk_bf16_f32 v106, v122, v123
    v_pk_fma_f32 v[90:91], v[66:67], v[80:81], v[90:91] op_sel:[1,1,0] op_sel_hi:[0,1,1] neg_lo:[0,1,0]
    v_pk_mul_f32 v[122:123], v[124:125], v[82:83] op_sel:[0,0] op_sel_hi:[1,0]
    v_cvt_pk_bf16_f32 v107, v90, -v91
    ds_write2_b32 v73, v105, v106 offset0:132 offset1:136
    v_pk_mul_f32 v[92:93], v[90:91], v[80:81] op_sel:[0,0] op_sel_hi:[1,0]
    v_pk_fma_f32 v[122:123], v[124:125], v[82:83], v[122:123] op_sel:[1,1,0] op_sel_hi:[0,1,1] neg_lo:[0,1,0]
    v_cvt_pk_bf16_f32 v108, v124, v125
    v_pk_fma_f32 v[92:93], v[90:91], v[80:81], v[92:93] op_sel:[1,1,0] op_sel_hi:[0,1,1] neg_lo:[0,1,0]
    v_pk_mul_f32 v[124:125], v[122:123], v[82:83] op_sel:[0,0] op_sel_hi:[1,0]
    v_cvt_pk_bf16_f32 v109, v92, -v93
    ds_write2_b32 v73, v107, v108 offset0:4 offset1:140
    v_pk_mul_f32 v[90:91], v[92:93], v[80:81] op_sel:[0,0] op_sel_hi:[1,0]
    s_add_u32 m0, s85, 8192
    s_add_u32 s86, s84, 8192
    buffer_load_dwordx4 v4, s[4:7], s86 offen offset:1024 lds
    v_pk_fma_f32 v[124:125], v[122:123], v[82:83], v[124:125] op_sel:[1,1,0] op_sel_hi:[0,1,1] neg_lo:[0,1,0]
    v_cvt_pk_bf16_f32 v110, v122, v123
    v_pk_fma_f32 v[90:91], v[92:93], v[80:81], v[90:91] op_sel:[1,1,0] op_sel_hi:[0,1,1] neg_lo:[0,1,0]
    v_pk_mul_f32 v[122:123], v[124:125], v[82:83] op_sel:[0,0] op_sel_hi:[1,0]
    v_cvt_pk_bf16_f32 v111, v90, -v91
    ds_write2_b32 v73, v109, v110 offset0:8 offset1:144
    v_pk_mul_f32 v[92:93], v[90:91], v[80:81] op_sel:[0,0] op_sel_hi:[1,0]
    v_pk_fma_f32 v[122:123], v[124:125], v[82:83], v[122:123] op_sel:[1,1,0] op_sel_hi:[0,1,1] neg_lo:[0,1,0]
    v_cvt_pk_bf16_f32 v112, v124, v125
    v_pk_fma_f32 v[92:93], v[90:91], v[80:81], v[92:93] op_sel:[1,1,0] op_sel_hi:[0,1,1] neg_lo:[0,1,0]
    v_pk_mul_f32 v[124:125], v[122:123], v[82:83] op_sel:[0,0] op_sel_hi:[1,0]
    v_cvt_pk_bf16_f32 v113, v92, -v93
    ds_write2_b32 v73, v111, v112 offset0:12 offset1:148
    v_pk_mul_f32 v[90:91], v[92:93], v[80:81] op_sel:[0,0] op_sel_hi:[1,0]
    v_pk_fma_f32 v[124:125], v[122:123], v[82:83], v[124:125] op_sel:[1,1,0] op_sel_hi:[0,1,1] neg_lo:[0,1,0]
    v_cvt_pk_bf16_f32 v114, v122, v123
    v_pk_fma_f32 v[90:91], v[92:93], v[80:81], v[90:91] op_sel:[1,1,0] op_sel_hi:[0,1,1] neg_lo:[0,1,0]
    v_pk_mul_f32 v[122:123], v[124:125], v[82:83] op_sel:[0,0] op_sel_hi:[1,0]
    v_cvt_pk_bf16_f32 v115, v90, -v91
    ds_write2_b32 v73, v113, v114 offset0:16 offset1:152
    v_pk_mul_f32 v[92:93], v[90:91], v[80:81] op_sel:[0,0] op_sel_hi:[1,0]
    v_pk_fma_f32 v[122:123], v[124:125], v[82:83], v[122:123] op_sel:[1,1,0] op_sel_hi:[0,1,1] neg_lo:[0,1,0]
    s_add_u32 m0, s85, 8192
    s_add_u32 s86, s84, 8192
    buffer_load_dwordx4 v4, s[4:7], s86 offen offset:2048 lds
    v_cvt_pk_bf16_f32 v116, v124, v125
    v_pk_fma_f32 v[92:93], v[90:91], v[80:81], v[92:93] op_sel:[1,1,0] op_sel_hi:[0,1,1] neg_lo:[0,1,0]
    v_pk_mul_f32 v[124:125], v[122:123], v[82:83] op_sel:[0,0] op_sel_hi:[1,0]
    v_cvt_pk_bf16_f32 v117, v92, -v93
    ds_write2_b32 v73, v115, v116 offset0:20 offset1:156
    v_pk_mul_f32 v[90:91], v[92:93], v[80:81] op_sel:[0,0] op_sel_hi:[1,0]
    v_pk_fma_f32 v[124:125], v[122:123], v[82:83], v[124:125] op_sel:[1,1,0] op_sel_hi:[0,1,1] neg_lo:[0,1,0]
    v_cvt_pk_bf16_f32 v118, v122, v123
    v_pk_fma_f32 v[90:91], v[92:93], v[80:81], v[90:91] op_sel:[1,1,0] op_sel_hi:[0,1,1] neg_lo:[0,1,0]
    v_pk_mul_f32 v[122:123], v[124:125], v[82:83] op_sel:[0,0] op_sel_hi:[1,0]
    v_cvt_pk_bf16_f32 v119, v90, -v91
    ds_write2_b32 v73, v117, v118 offset0:24 offset1:160
    v_pk_mul_f32 v[88:89], v[86:87], v[86:87] op_sel:[0,0] op_sel_hi:[1,0]
    v_pk_fma_f32 v[122:123], v[124:125], v[82:83], v[122:123] op_sel:[1,1,0] op_sel_hi:[0,1,1] neg_lo:[0,1,0]
    v_cvt_pk_bf16_f32 v104, v124, v125
    v_pk_fma_f32 v[88:89], v[86:87], v[86:87], v[88:89] op_sel:[1,1,0] op_sel_hi:[0,1,1] neg_lo:[0,1,0]
    v_pk_mul_f32 v[124:125], v[122:123], v[82:83] op_sel:[0,0] op_sel_hi:[1,0]
    v_pk_mul_f32 v[94:95], v[66:67], v[84:85] op_sel:[0,0] op_sel_hi:[1,0]
    v_pk_fma_f32 v[124:125], v[122:123], v[82:83], v[124:125] op_sel:[1,1,0] op_sel_hi:[0,1,1] neg_lo:[0,1,0]
    v_cvt_pk_bf16_f32 v105, v122, v123
    ds_write2_b32 v73, v119, v104 offset0:28 offset1:164
    v_pk_fma_f32 v[94:95], v[66:67], v[84:85], v[94:95] op_sel:[1,1,0] op_sel_hi:[0,1,1] neg_lo:[0,1,0]
    s_add_u32 m0, s85, 8192
    s_add_u32 s86, s84, 8192
    buffer_load_dwordx4 v4, s[4:7], s86 offen offset:3072 lds
    v_pk_mul_f32 v[122:123], v[124:125], v[82:83] op_sel:[0,0] op_sel_hi:[1,0]
    v_cvt_pk_bf16_f32 v106, v94, -v95
    v_pk_mul_f32 v[90:91], v[94:95], v[86:87] op_sel:[0,0] op_sel_hi:[1,0]
    v_pk_fma_f32 v[122:123], v[124:125], v[82:83], v[122:123] op_sel:[1,1,0] op_sel_hi:[0,1,1] neg_lo:[0,1,0]
    v_cvt_pk_bf16_f32 v107, v124, v125
    ds_write2_b32 v73, v105, v106 offset0:168 offset1:32
    v_pk_fma_f32 v[90:91], v[94:95], v[86:87], v[90:91] op_sel:[1,1,0] op_sel_hi:[0,1,1] neg_lo:[0,1,0]
    v_pk_mul_f32 v[124:125], v[122:123], v[82:83] op_sel:[0,0] op_sel_hi:[1,0]
    v_cvt_pk_bf16_f32 v108, v90, -v91
    v_pk_mul_f32 v[92:93], v[90:91], v[86:87] op_sel:[0,0] op_sel_hi:[1,0]
    v_pk_fma_f32 v[124:125], v[122:123], v[82:83], v[124:125] op_sel:[1,1,0] op_sel_hi:[0,1,1] neg_lo:[0,1,0]
    v_cvt_pk_bf16_f32 v109, v122, v123
    ds_write2_b32 v73, v107, v108 offset0:172 offset1:36
    v_pk_fma_f32 v[92:93], v[90:91], v[86:87], v[92:93] op_sel:[1,1,0] op_sel_hi:[0,1,1] neg_lo:[0,1,0]
    v_pk_mul_f32 v[122:123], v[124:125], v[82:83] op_sel:[0,0] op_sel_hi:[1,0]
    v_cvt_pk_bf16_f32 v110, v92, -v93
    ds_write2_b32 v73, v109, v110 offset0:176 offset1:40
    v_pk_mul_f32 v[90:91], v[92:93], v[86:87] op_sel:[0,0] op_sel_hi:[1,0]
    v_pk_fma_f32 v[122:123], v[124:125], v[82:83], v[122:123] op_sel:[1,1,0] op_sel_hi:[0,1,1] neg_lo:[0,1,0]
    v_cvt_pk_bf16_f32 v111, v124, v125
    v_pk_fma_f32 v[90:91], v[92:93], v[86:87], v[90:91] op_sel:[1,1,0] op_sel_hi:[0,1,1] neg_lo:[0,1,0]
    v_pk_mul_f32 v[124:125], v[122:123], v[82:83] op_sel:[0,0] op_sel_hi:[1,0]
    s_add_u32 m0, s85, 12288
    s_add_u32 s86, s84, 12288
    buffer_load_dwordx4 v4, s[4:7], s86 offen offset:0 lds
    v_cvt_pk_bf16_f32 v112, v90, -v91
    ds_write2_b32 v73, v110, v111 offset0:48 offset1:180
    v_pk_mul_f32 v[92:93], v[90:91], v[86:87] op_sel:[0,0] op_sel_hi:[1,0]
    v_pk_fma_f32 v[124:125], v[122:123], v[82:83], v[124:125] op_sel:[1,1,0] op_sel_hi:[0,1,1] neg_lo:[0,1,0]
    v_cvt_pk_bf16_f32 v113, v122, v123
    v_pk_fma_f32 v[92:93], v[90:91], v[86:87], v[92:93] op_sel:[1,1,0] op_sel_hi:[0,1,1] neg_lo:[0,1,0]
    v_pk_mul_f32 v[122:123], v[124:125], v[82:83] op_sel:[0,0] op_sel_hi:[1,0]
    v_cvt_pk_bf16_f32 v114, v92, -v93
    ds_write2_b32 v73, v112, v113 offset0:52 offset1:184
    v_pk_mul_f32 v[66:67], v[94:95], v[84:85] op_sel:[0,0] op_sel_hi:[1,0]
    v_pk_fma_f32 v[122:123], v[124:125], v[82:83], v[122:123] op_sel:[1,1,0] op_sel_hi:[0,1,1] neg_lo:[0,1,0]
    v_cvt_pk_bf16_f32 v115, v124, v125
    v_pk_fma_f32 v[66:67], v[94:95], v[84:85], v[66:67] op_sel:[1,1,0] op_sel_hi:[0,1,1] neg_lo:[0,1,0]
    v_pk_mul_f32 v[124:125], v[122:123], v[82:83] op_sel:[0,0] op_sel_hi:[1,0]
    v_cvt_pk_bf16_f32 v116, v66, -v67
    ds_write2_b32 v73, v114, v115 offset0:56 offset1:188
    v_pk_mul_f32 v[90:91], v[66:67], v[88:89] op_sel:[0,0] op_sel_hi:[1,0]
    v_pk_fma_f32 v[124:125], v[122:123], v[82:83], v[124:125] op_sel:[1,1,0] op_sel_hi:[0,1,1] neg_lo:[0,1,0]
    v_cvt_pk_bf16_f32 v117, v122, v123
    v_pk_fma_f32 v[90:91], v[66:67], v[88:89], v[90:91] op_sel:[1,1,0] op_sel_hi:[0,1,1] neg_lo:[0,1,0]
    v_pk_mul_f32 v[122:123], v[124:125], v[82:83] op_sel:[0,0] op_sel_hi:[1,0]
    v_cvt_pk_bf16_f32 v118, v90, -v91
    s_add_u32 m0, s85, 12288
    s_add_u32 s86, s84, 12288
    buffer_load_dwordx4 v4, s[4:7], s86 offen offset:1024 lds
    ds_write2_b32 v73, v116, v117 offset0:64 offset1:192
    v_pk_mul_f32 v[92:93], v[66:67], v[82:83] op_sel:[0,0] op_sel_hi:[1,0]
    v_pk_fma_f32 v[122:123], v[124:125], v[82:83], v[122:123] op_sel:[1,1,0] op_sel_hi:[0,1,1] neg_lo:[0,1,0]
    v_cvt_pk_bf16_f32 v119, v124, v125
    v_pk_fma_f32 v[92:93], v[66:67], v[82:83], v[92:93] op_sel:[1,1,0] op_sel_hi:[0,1,1] neg_lo:[0,1,0]
    v_pk_mul_f32 v[124:125], v[122:123], v[82:83] op_sel:[0,0] op_sel_hi:[1,0]
    v_cvt_pk_bf16_f32 v104, v92, -v93
    ds_write2_b32 v73, v118, v119 offset0:68 offset1:196
    v_pk_mul_f32 v[94:95], v[66:67], v[84:85] op_sel:[0,0] op_sel_hi:[1,0]
    v_pk_fma_f32 v[124:125], v[122:123], v[82:83], v[124:125] op_sel:[1,1,0] op_sel_hi:[0,1,1] neg_lo:[0,1,0]
    v_cvt_pk_bf16_f32 v105, v122, v123
    v_pk_fma_f32 v[94:95], v[66:67], v[84:85], v[94:95] op_sel:[1,1,0] op_sel_hi:[0,1,1] neg_lo:[0,1,0]
    v_pk_mul_f32 v[122:123], v[124:125], v[82:83] op_sel:[0,0] op_sel_hi:[1,0]
    v_cvt_pk_bf16_f32 v106, v94, -v95
    ds_write2_b32 v73, v104, v105 offset0:72 offset1:200
    v_pk_mul_f32 v[90:91], v[94:95], v[88:89] op_sel:[0,0] op_sel_hi:[1,0]
    v_pk_fma_f32 v[122:123], v[124:125], v[82:83], v[122:123] op_sel:[1,1,0] op_sel_hi:[0,1,1] neg_lo:[0,1,0]
    v_cvt_pk_bf16_f32 v107, v124, v125
    v_pk_fma_f32 v[90:91], v[94:95], v[88:89], v[90:91] op_sel:[1,1,0] op_sel_hi:[0,1,1] neg_lo:[0,1,0]
    v_pk_mul_f32 v[124:125], v[122:123], v[82:83] op_sel:[0,0] op_sel_hi:[1,0]
    v_cvt_pk_bf16_f32 v108, v90, -v91
    ds_write2_b32 v73, v106, v107 offset0:80 offset1:204
    s_add_u32 m0, s85, 12288
    s_add_u32 s86, s84, 12288
    buffer_load_dwordx4 v4, s[4:7], s86 offen offset:2048 lds
    v_pk_mul_f32 v[92:93], v[94:95], v[82:83] op_sel:[0,0] op_sel_hi:[1,0]
    v_pk_fma_f32 v[124:125], v[122:123], v[82:83], v[124:125] op_sel:[1,1,0] op_sel_hi:[0,1,1] neg_lo:[0,1,0]
    v_cvt_pk_bf16_f32 v109, v122, v123
    v_pk_fma_f32 v[92:93], v[94:95], v[82:83], v[92:93] op_sel:[1,1,0] op_sel_hi:[0,1,1] neg_lo:[0,1,0]
    v_pk_mul_f32 v[122:123], v[124:125], v[82:83] op_sel:[0,0] op_sel_hi:[1,0]
    v_cvt_pk_bf16_f32 v110, v92, -v93
    ds_write2_b32 v73, v108, v109 offset0:84 offset1:208
    v_pk_mul_f32 v[66:67], v[94:95], v[84:85] op_sel:[0,0] op_sel_hi:[1,0]
    v_pk_fma_f32 v[122:123], v[124:125], v[82:83], v[122:123] op_sel:[1,1,0] op_sel_hi:[0,1,1] neg_lo:[0,1,0]
    v_cvt_pk_bf16_f32 v111, v124, v125
    v_pk_fma_f32 v[66:67], v[94:95], v[84:85], v[66:67] op_sel:[1,1,0] op_sel_hi:[0,1,1] neg_lo:[0,1,0]
    v_pk_mul_f32 v[124:125], v[122:123], v[82:83] op_sel:[0,0] op_sel_hi:[1,0]
    v_cvt_pk_bf16_f32 v112, v66, -v67
    ds_write2_b32 v73, v110, v111 offset0:88 offset1:212
    v_pk_mul_f32 v[90:91], v[66:67], v[82:83] op_sel:[0,0] op_sel_hi:[1,0]
    v_pk_fma_f32 v[124:125], v[122:123], v[82:83], v[124:125] op_sel:[1,1,0] op_sel_hi:[0,1,1] neg_lo:[0,1,0]
    v_cvt_pk_bf16_f32 v113, v122, v123
    v_pk_fma_f32 v[90:91], v[66:67], v[82:83], v[90:91] op_sel:[1,1,0] op_sel_hi:[0,1,1] neg_lo:[0,1,0]
    v_pk_mul_f32 v[122:123], v[124:125], v[82:83] op_sel:[0,0] op_sel_hi:[1,0]
    v_cvt_pk_bf16_f32 v114, v90, -v91
    ds_write2_b32 v73, v112, v113 offset0:96 offset1:216
    v_pk_mul_f32 v[94:95], v[66:67], v[84:85] op_sel:[0,0] op_sel_hi:[1,0]
    s_add_u32 m0, s85, 12288
    s_add_u32 s86, s84, 12288
    buffer_load_dwordx4 v4, s[4:7], s86 offen offset:3072 lds
    v_pk_fma_f32 v[122:123], v[124:125], v[82:83], v[122:123] op_sel:[1,1,0] op_sel_hi:[0,1,1] neg_lo:[0,1,0]
    v_cvt_pk_bf16_f32 v115, v124, v125
    v_pk_fma_f32 v[94:95], v[66:67], v[84:85], v[94:95] op_sel:[1,1,0] op_sel_hi:[0,1,1] neg_lo:[0,1,0]
    v_pk_mul_f32 v[124:125], v[122:123], v[82:83] op_sel:[0,0] op_sel_hi:[1,0]
    v_cvt_pk_bf16_f32 v116, v94, -v95
    ds_write2_b32 v73, v114, v115 offset0:100 offset1:220
    v_pk_mul_f32 v[90:91], v[94:95], v[82:83] op_sel:[0,0] op_sel_hi:[1,0]
    v_pk_fma_f32 v[124:125], v[122:123], v[82:83], v[124:125] op_sel:[1,1,0] op_sel_hi:[0,1,1] neg_lo:[0,1,0]
    v_cvt_pk_bf16_f32 v117, v122, v123
    v_pk_fma_f32 v[90:91], v[94:95], v[82:83], v[90:91] op_sel:[1,1,0] op_sel_hi:[0,1,1] neg_lo:[0,1,0]
    v_pk_mul_f32 v[122:123], v[124:125], v[82:83] op_sel:[0,0] op_sel_hi:[1,0]
    v_cvt_pk_bf16_f32 v118, v90, -v91
    ds_write2_b32 v73, v116, v117 offset0:104 offset1:224
    v_pk_mul_f32 v[66:67], v[94:95], v[84:85] op_sel:[0,0] op_sel_hi:[1,0]
    v_pk_fma_f32 v[122:123], v[124:125], v[82:83], v[122:123] op_sel:[1,1,0] op_sel_hi:[0,1,1] neg_lo:[0,1,0]
    v_cvt_pk_bf16_f32 v119, v124, v125
    v_pk_fma_f32 v[66:67], v[94:95], v[84:85], v[66:67] op_sel:[1,1,0] op_sel_hi:[0,1,1] neg_lo:[0,1,0]
    v_pk_mul_f32 v[124:125], v[122:123], v[82:83] op_sel:[0,0] op_sel_hi:[1,0]
    v_cvt_pk_bf16_f32 v104, v66, -v67
    ds_write2_b32 v73, v118, v119 offset0:108 offset1:228
    v_pk_mul_f32 v[90:91], v[66:67], v[82:83] op_sel:[0,0] op_sel_hi:[1,0]
    v_pk_fma_f32 v[124:125], v[122:123], v[82:83], v[124:125] op_sel:[1,1,0] op_sel_hi:[0,1,1] neg_lo:[0,1,0]
    buffer_load_dwordx2 v[30:31], v26, s[24:27], 0 offen sc1
    v_cvt_pk_bf16_f32 v105, v122, v123
    v_pk_fma_f32 v[90:91], v[66:67], v[82:83], v[90:91] op_sel:[1,1,0] op_sel_hi:[0,1,1] neg_lo:[0,1,0]
    v_pk_mul_f32 v[122:123], v[124:125], v[82:83] op_sel:[0,0] op_sel_hi:[1,0]
    v_cvt_pk_bf16_f32 v106, v90, -v91
    ds_write2_b32 v73, v104, v105 offset0:112 offset1:232
    v_pk_mul_f32 v[94:95], v[66:67], v[84:85] op_sel:[0,0] op_sel_hi:[1,0]
    v_pk_fma_f32 v[122:123], v[124:125], v[82:83], v[122:123] op_sel:[1,1,0] op_sel_hi:[0,1,1] neg_lo:[0,1,0]
    v_cvt_pk_bf16_f32 v107, v124, v125
    v_pk_fma_f32 v[94:95], v[66:67], v[84:85], v[94:95] op_sel:[1,1,0] op_sel_hi:[0,1,1] neg_lo:[0,1,0]
    v_pk_mul_f32 v[124:125], v[122:123], v[82:83] op_sel:[0,0] op_sel_hi:[1,0]
    v_cvt_pk_bf16_f32 v108, v94, -v95
    ds_write2_b32 v73, v106, v107 offset0:116 offset1:236
    v_pk_mul_f32 v[90:91], v[94:95], v[82:83] op_sel:[0,0] op_sel_hi:[1,0]
    v_pk_fma_f32 v[124:125], v[122:123], v[82:83], v[124:125] op_sel:[1,1,0] op_sel_hi:[0,1,1] neg_lo:[0,1,0]
    v_cvt_pk_bf16_f32 v109, v122, v123
    v_pk_fma_f32 v[90:91], v[94:95], v[82:83], v[90:91] op_sel:[1,1,0] op_sel_hi:[0,1,1] neg_lo:[0,1,0]
    v_pk_mul_f32 v[122:123], v[124:125], v[82:83] op_sel:[0,0] op_sel_hi:[1,0]
    v_cvt_pk_bf16_f32 v110, v90, -v91
    ds_write2_b32 v73, v108, v109 offset0:120 offset1:44
    v_pk_fma_f32 v[122:123], v[124:125], v[82:83], v[122:123] op_sel:[1,1,0] op_sel_hi:[0,1,1] neg_lo:[0,1,0]
    v_cvt_pk_bf16_f32 v111, v124, v125
    v_pk_mul_f32 v[124:125], v[122:123], v[82:83] op_sel:[0,0] op_sel_hi:[1,0]
    s_add_u32 m0, s92, 68608
    s_nop 0
    buffer_load_dwordx4 v36, s[12:15], 0 offen offset:0 lds
    v_pk_fma_f32 v[124:125], v[122:123], v[82:83], v[124:125] op_sel:[1,1,0] op_sel_hi:[0,1,1] neg_lo:[0,1,0]
    v_cvt_pk_bf16_f32 v112, v122, v123
    ds_write2_b32 v73, v110, v111 offset0:124 offset1:60
    v_cvt_pk_bf16_f32 v113, v124, v125
    ds_write2_b32 v73, v112, v113 offset0:76 offset1:92
    buffer_load_dwordx4 v37, s[12:15], 0 offen offset:1024 lds
    buffer_load_dwordx4 v28, s[12:15], 0 offen offset:2048 lds
    buffer_load_dwordx4 v42, s[12:15], 0 offen offset:3072 lds
    s_add_u32 m0, s92, 84992
    s_nop 0
    buffer_load_dwordx4 v36, s[12:15], s33 offen offset:0 lds
    buffer_load_dwordx4 v37, s[12:15], s33 offen offset:1024 lds
    buffer_load_dwordx4 v28, s[12:15], s33 offen offset:2048 lds
    buffer_load_dwordx4 v42, s[12:15], s33 offen offset:3072 lds
    s_waitcnt vmcnt(9)
    s_waitcnt lgkmcnt(0)
    s_barrier
    s_mov_b32 s96, 0x05040100
    s_mov_b32 s97, 0x07060302
    ds_read_b128 v[64:67], v8 offset:0
    ds_read_b128 v[68:71], v8 offset:1024
    ds_read_b128 v[72:75], v8 offset:2048
    ds_read_b128 v[76:79], v8 offset:3072
    ds_read_b128 v[80:83], v8 offset:4096
    ds_read_b128 v[84:87], v8 offset:5120
    ds_read_b128 v[88:91], v8 offset:6144
    ds_read_b128 v[92:95], v8 offset:7168
    ds_read_b128 v[96:99], v9 offset:0
    ds_read_b128 v[100:103], v9 offset:1024
    ds_read_b128 v[104:107], v9 offset:2048
    ds_read_b128 v[108:111], v9 offset:3072
    ds_read_b128 v[112:115], v9 offset:4096
    ds_read_b128 v[116:119], v9 offset:5120
    ds_read_b128 v[120:123], v9 offset:6144
    ds_read_b128 v[124:127], v9 offset:7168
    s_waitcnt lgkmcnt(8)
    v_perm_b32 v128, v68, v64, s96
    v_perm_b32 v129, v76, v72, s96
    v_perm_b32 v130, v84, v80, s96
    v_perm_b32 v131, v92, v88, s96
    buffer_store_dwordx4 v[128:131], v10, s[16:19], s76 offen sc1
    v_perm_b32 v132, v68, v64, s97
    v_perm_b32 v133, v76, v72, s97
    v_perm_b32 v134, v84, v80, s97
    v_perm_b32 v135, v92, v88, s97
    buffer_store_dwordx4 v[132:135], v10, s[16:19], s77 offen sc1
    v_perm_b32 v136, v69, v65, s96
    v_perm_b32 v137, v77, v73, s96
    v_perm_b32 v138, v85, v81, s96
    v_perm_b32 v139, v93, v89, s96
    buffer_store_dwordx4 v[136:139], v10, s[16:19], s78 offen sc1
    v_perm_b32 v140, v69, v65, s97
    v_perm_b32 v141, v77, v73, s97
    v_perm_b32 v142, v85, v81, s97
    v_perm_b32 v143, v93, v89, s97
    buffer_store_dwordx4 v[140:143], v10, s[16:19], s79 offen sc1
    v_perm_b32 v144, v70, v66, s96
    v_perm_b32 v145, v78, v74, s96
    v_perm_b32 v146, v86, v82, s96
    v_perm_b32 v147, v94, v90, s96
    buffer_store_dwordx4 v[144:147], v10, s[16:19], s80 offen sc1
    v_perm_b32 v148, v70, v66, s97
    v_perm_b32 v149, v78, v74, s97
    v_perm_b32 v150, v86, v82, s97
    v_perm_b32 v151, v94, v90, s97
    buffer_store_dwordx4 v[148:151], v10, s[16:19], s81 offen sc1
    v_perm_b32 v152, v71, v67, s96
    v_perm_b32 v153, v79, v75, s96
    v_perm_b32 v154, v87, v83, s96
    v_perm_b32 v155, v95, v91, s96
    buffer_store_dwordx4 v[152:155], v10, s[16:19], s82 offen sc1
    v_perm_b32 v156, v71, v67, s97
    v_perm_b32 v157, v79, v75, s97
    v_perm_b32 v158, v87, v83, s97
    v_perm_b32 v159, v95, v91, s97
    buffer_store_dwordx4 v[156:159], v10, s[16:19], s83 offen sc1
    s_waitcnt lgkmcnt(0)
    v_perm_b32 v160, v100, v96, s96
    v_perm_b32 v161, v108, v104, s96
    v_perm_b32 v162, v116, v112, s96
    v_perm_b32 v163, v124, v120, s96
    buffer_store_dwordx4 v[160:163], v11, s[16:19], s76 offen sc1
    v_perm_b32 v164, v100, v96, s97
    v_perm_b32 v165, v108, v104, s97
    v_perm_b32 v166, v116, v112, s97
    v_perm_b32 v167, v124, v120, s97
    buffer_store_dwordx4 v[164:167], v11, s[16:19], s77 offen sc1
    v_perm_b32 v168, v101, v97, s96
    v_perm_b32 v169, v109, v105, s96
    v_perm_b32 v170, v117, v113, s96
    v_perm_b32 v171, v125, v121, s96
    buffer_store_dwordx4 v[168:171], v11, s[16:19], s78 offen sc1
    v_perm_b32 v172, v101, v97, s97
    v_perm_b32 v173, v109, v105, s97
    v_perm_b32 v174, v117, v113, s97
    v_perm_b32 v175, v125, v121, s97
    buffer_store_dwordx4 v[172:175], v11, s[16:19], s79 offen sc1
    v_perm_b32 v176, v102, v98, s96
    v_perm_b32 v177, v110, v106, s96
    v_perm_b32 v178, v118, v114, s96
    v_perm_b32 v179, v126, v122, s96
    buffer_store_dwordx4 v[176:179], v11, s[16:19], s80 offen sc1
    v_perm_b32 v180, v102, v98, s97
    v_perm_b32 v181, v110, v106, s97
    v_perm_b32 v182, v118, v114, s97
    v_perm_b32 v183, v126, v122, s97
    buffer_store_dwordx4 v[180:183], v11, s[16:19], s81 offen sc1
    v_perm_b32 v184, v103, v99, s96
    v_perm_b32 v185, v111, v107, s96
    v_perm_b32 v186, v119, v115, s96
    v_perm_b32 v187, v127, v123, s96
    buffer_store_dwordx4 v[184:187], v11, s[16:19], s82 offen sc1
    v_perm_b32 v188, v103, v99, s97
    v_perm_b32 v189, v111, v107, s97
    v_perm_b32 v190, v119, v115, s97
    v_perm_b32 v191, v127, v123, s97
    buffer_store_dwordx4 v[188:191], v11, s[16:19], s83 offen sc1
    v_dot2_f32_bf16 v14, v64, v232, 0
    v_dot2_f32_bf16 v14, v65, v233, v14
    v_dot2_f32_bf16 v14, v66, v234, v14
    v_dot2_f32_bf16 v14, v67, v235, v14
    v_dot2_f32_bf16 v14, v96, v236, v14
    v_dot2_f32_bf16 v14, v97, v237, v14
    v_dot2_f32_bf16 v14, v98, v238, v14
    v_dot2_f32_bf16 v14, v99, v239, v14
    v_dot2_f32_bf16 v15, v68, v232, 0
    v_dot2_f32_bf16 v15, v69, v233, v15
    v_dot2_f32_bf16 v15, v70, v234, v15
    v_dot2_f32_bf16 v15, v71, v235, v15
    v_dot2_f32_bf16 v15, v100, v236, v15
    v_dot2_f32_bf16 v15, v101, v237, v15
    v_dot2_f32_bf16 v15, v102, v238, v15
    v_dot2_f32_bf16 v15, v103, v239, v15
    v_dot2_f32_bf16 v16, v72, v232, 0
    v_dot2_f32_bf16 v16, v73, v233, v16
    v_dot2_f32_bf16 v16, v74, v234, v16
    v_dot2_f32_bf16 v16, v75, v235, v16
    v_dot2_f32_bf16 v16, v104, v236, v16
    v_dot2_f32_bf16 v16, v105, v237, v16
    v_dot2_f32_bf16 v16, v106, v238, v16
    v_dot2_f32_bf16 v16, v107, v239, v16
    v_dot2_f32_bf16 v17, v76, v232, 0
    v_dot2_f32_bf16 v17, v77, v233, v17
    v_dot2_f32_bf16 v17, v78, v234, v17
    v_dot2_f32_bf16 v17, v79, v235, v17
    v_dot2_f32_bf16 v17, v108, v236, v17
    v_dot2_f32_bf16 v17, v109, v237, v17
    v_dot2_f32_bf16 v17, v110, v238, v17
    v_dot2_f32_bf16 v17, v111, v239, v17
    v_dot2_f32_bf16 v18, v80, v232, 0
    v_dot2_f32_bf16 v18, v81, v233, v18
    v_dot2_f32_bf16 v18, v82, v234, v18
    v_dot2_f32_bf16 v18, v83, v235, v18
    v_dot2_f32_bf16 v18, v112, v236, v18
    v_dot2_f32_bf16 v18, v113, v237, v18
    v_dot2_f32_bf16 v18, v114, v238, v18
    v_dot2_f32_bf16 v18, v115, v239, v18
    v_dot2_f32_bf16 v19, v84, v232, 0
    v_dot2_f32_bf16 v19, v85, v233, v19
    v_dot2_f32_bf16 v19, v86, v234, v19
    v_dot2_f32_bf16 v19, v87, v235, v19
    v_dot2_f32_bf16 v19, v116, v236, v19
    v_dot2_f32_bf16 v19, v117, v237, v19
    v_dot2_f32_bf16 v19, v118, v238, v19
    v_dot2_f32_bf16 v19, v119, v239, v19
    v_dot2_f32_bf16 v20, v88, v232, 0
    v_dot2_f32_bf16 v20, v89, v233, v20
    v_dot2_f32_bf16 v20, v90, v234, v20
    v_dot2_f32_bf16 v20, v91, v235, v20
    v_dot2_f32_bf16 v20, v120, v236, v20
    v_dot2_f32_bf16 v20, v121, v237, v20
    v_dot2_f32_bf16 v20, v122, v238, v20
    v_dot2_f32_bf16 v20, v123, v239, v20
    v_dot2_f32_bf16 v21, v92, v232, 0
    v_dot2_f32_bf16 v21, v93, v233, v21
    v_dot2_f32_bf16 v21, v94, v234, v21
    v_dot2_f32_bf16 v21, v95, v235, v21
    v_dot2_f32_bf16 v21, v124, v236, v21
    v_dot2_f32_bf16 v21, v125, v237, v21
    v_dot2_f32_bf16 v21, v126, v238, v21
    v_dot2_f32_bf16 v21, v127, v239, v21
    s_waitcnt vmcnt(24)
    v_cmp_eq_u32 vcc, 0, v31
    s_nop 1
    s_cbranch_vccnz slow_16
ret_17:
    v_readfirstlane_b32 s63, v30
    v_mov_b32 v29, v30
    s_lshl_b32 s30, s60, 10
    s_lshl_b32 s31, s64, 2
    s_add_u32 s30, s30, s31
    s_waitcnt vmcnt(0)
    s_mov_b64 exec, 255
    buffer_store_dword v29, v12, s[16:19], s30 offen offset:0 sc1
    s_mov_b64 exec, -1
    ds_read_b128 a[96:99], v226 offset:0
    ds_read_b128 a[100:103], v227 offset:0
    ds_read_b128 a[104:107], v226 offset:1952
    ds_read_b128 a[108:111], v227 offset:1952
    ds_read_b128 a[112:115], v226 offset:3904
    ds_read_b128 a[116:119], v227 offset:3904
    ds_read_b128 a[120:123], v226 offset:5856
    ds_read_b128 a[124:127], v227 offset:5856
    s_waitcnt lgkmcnt(6)
    v_mfma_f32_32x32x16_bf16 v[192:207], a[96:99], a[100:103], 0
    ds_read_b128 a[128:131], v226 offset:7808
    ds_read_b128 a[132:135], v227 offset:7808
    s_waitcnt lgkmcnt(6)
    v_mfma_f32_32x32x16_bf16 v[192:207], a[104:107], a[108:111], v[192:207]
    ds_read_b128 a[136:139], v226 offset:9760
    ds_read_b128 a[140:143], v227 offset:9760
    s_waitcnt lgkmcnt(6)
    v_mfma_f32_32x32x16_bf16 v[192:207], a[112:115], a[116:119], v[192:207]
    ds_read_b128 a[144:147], v226 offset:11712
    ds_read_b128 a[148:151], v227 offset:11712
    ds_read_b128 a[152:155], v226 offset:13664
    ds_read_b128 a[156:159], v227 offset:13664
    s_waitcnt lgkmcnt(8)
    v_mfma_f32_32x32x16_bf16 v[192:207], a[120:123], a[124:127], v[192:207]
    ds_read_b128 a[160:163], v226 offset:15616
    ds_read_b128 a[164:167], v227 offset:15616
    s_waitcnt lgkmcnt(8)
    v_mfma_f32_32x32x16_bf16 v[192:207], a[128:131], a[132:135], v[192:207]
    ds_read_b128 a[168:171], v226 offset:17568
    ds_read_b128 a[172:175], v227 offset:17568
    s_waitcnt lgkmcnt(8)
    v_mfma_f32_32x32x16_bf16 v[192:207], a[136:139], a[140:143], v[192:207]
    ds_read_b128 a[176:179], v226 offset:19520
    ds_read_b128 a[180:183], v227 offset:19520
    ds_read_b128 a[184:187], v226 offset:21472
    ds_read_b128 a[188:191], v227 offset:21472
    s_waitcnt lgkmcnt(10)
    v_mfma_f32_32x32x16_bf16 v[192:207], a[144:147], a[148:151], v[192:207]
    ds_read_b128 a[192:195], v226 offset:23424
    ds_read_b128 a[196:199], v227 offset:23424
    s_waitcnt lgkmcnt(10)
    v_mfma_f32_32x32x16_bf16 v[192:207], a[152:155], a[156:159], v[192:207]
    ds_read_b128 a[200:203], v226 offset:25376
    ds_read_b128 a[204:207], v227 offset:25376
    s_waitcnt lgkmcnt(10)
    v_mfma_f32_32x32x16_bf16 v[192:207], a[160:163], a[164:167], v[192:207]
    ds_read_b128 a[208:211], v226 offset:27328
    ds_read_b128 a[212:215], v227 offset:27328
    ds_read_b128 a[216:219], v226 offset:29280
    ds_read_b128 a[220:223], v227 offset:29280
    s_waitcnt lgkmcnt(12)
    v_mfma_f32_32x32x16_bf16 v[192:207], a[168:171], a[172:175], v[192:207]
    s_waitcnt lgkmcnt(10)
    v_mfma_f32_32x32x16_bf16 v[192:207], a[176:179], a[180:183], v[192:207]
    s_waitcnt lgkmcnt(8)
    v_mfma_f32_32x32x16_bf16 v[192:207], a[184:187], a[188:191], v[192:207]
    s_waitcnt lgkmcnt(0)
    s_barrier
    v_mfma_f32_32x32x16_bf16 v[192:207], a[192:195], a[196:199], v[192:207]
    v_mfma_f32_32x32x16_bf16 v[192:207], a[200:203], a[204:207], v[192:207]
    v_mfma_f32_32x32x16_bf16 v[192:207], a[208:211], a[212:215], v[192:207]
    v_mfma_f32_32x32x16_bf16 v[192:207], a[216:219], a[220:223], v[192:207]
    v_permlane32_swap_b32 v14, v15
    v_add_f32 v14, v14, v15
    v_permlane32_swap_b32 v16, v17
    v_add_f32 v16, v16, v17
    v_permlane32_swap_b32 v18, v19
    v_add_f32 v18, v18, v19
    v_permlane32_swap_b32 v20, v21
    v_add_f32 v20, v20, v21
    v_permlane16_swap_b32 v14, v16
    v_add_f32 v14, v14, v16
    v_permlane16_swap_b32 v18, v20
    v_add_f32 v18, v18, v20
    v_add_f32_dpp v14, v14, v14 row_ror:8 row_mask:0xf bank_mask:0xf
    s_nop 0
    v_add_f32_dpp v18, v18, v18 row_ror:8 row_mask:0xf bank_mask:0xf
    v_bfe_u32 v64, v1, 3, 1
    v_cmp_eq_u32 vcc, 0, v64
    s_nop 1
    v_cndmask_b32 v14, v18, v14, vcc
    v_bfe_u32 v65, v1, 4, 1
    v_lshrrev_b32 v66, 5, v1
    v_lshl_add_u32 v65, v65, 1, v66
    v_lshl_add_u32 v65, v64, 2, v65
    v_lshl_add_u32 v65, v5, 3, v65
    s_lshl_b32 s30, s60, 8
    s_add_u32 s30, s30, 102400
    v_lshl_add_u32 v65, v65, 2, s30
    ds_write_b32 v65, v14
    ds_write_b128 v224, v[240:243] offset:4192
    v_mov_b32 v112, v195
    s_add_u32 m0, s92, 35840
    s_nop 0
    buffer_load_dwordx4 v36, s[12:15], s34 offen offset:0 lds
    v_mov_b32 v113, v195
    v_cndmask_b32 v96, v201, v202, s[66:67]
    buffer_load_dwordx4 v37, s[12:15], s34 offen offset:1024 lds
    v_cndmask_b32 v97, v200, v201, s[66:67]
    v_permlane32_swap_b32 v112, v113
    buffer_load_dwordx4 v28, s[12:15], s34 offen offset:2048 lds
    v_cvt_pk_bf16_f32 v100, v202, v96
    v_cvt_pk_bf16_f32 v101, v201, v201
    buffer_load_dwordx4 v42, s[12:15], s34 offen offset:3072 lds
    v_cvt_pk_bf16_f32 v102, v97, v200
    v_cvt_pk_bf16_f32 v103, v200, v200
    s_add_u32 m0, s92, 52224
    s_nop 0
    buffer_load_dwordx4 v36, s[12:15], s35 offen offset:0 lds
    ds_write_b128 v224, v[100:103] offset:3056
    v_mov_b32_dpp v114, v113 wave_ror:1 row_mask:0xf bank_mask:0xf
    buffer_load_dwordx4 v37, s[12:15], s35 offen offset:1024 lds
    v_mov_b32_dpp v112, v113 wave_shr:1 row_mask:0x3 bank_mask:0xf bound_ctrl:0
    v_add_f32 v192, v192, v228
    buffer_load_dwordx4 v28, s[12:15], s35 offen offset:2048 lds
    v_cndmask_b32 v96, v204, v205, s[68:69]
    v_cndmask_b32 v97, v204, v205, s[70:71]
    buffer_load_dwordx4 v42, s[12:15], s35 offen offset:3072 lds
    v_cvt_pk_bf16_f32 v104, v205, v205
    v_cvt_pk_bf16_f32 v105, v96, v97
    v_cvt_pk_bf16_f32 v106, v204, v204
    v_cvt_pk_bf16_f32 v107, v204, v204
    ds_write_b128 v225, v[104:107] offset:2032
    v_cndmask_b32 v96, v206, v207, s[68:69]
    v_cndmask_b32 v97, v206, v207, s[70:71]
    v_cvt_pk_bf16_f32 v108, v207, v207
    v_cvt_pk_bf16_f32 v109, v96, v97
    v_cvt_pk_bf16_f32 v110, v206, v206
    v_cvt_pk_bf16_f32 v111, v206, v206
    ds_write_b128 v225, v[108:111] offset:1520
    v_cmp_eq_u32 vcc, 0, v229
    s_nop 1
    v_cndmask_b32 v114, v196, v114, vcc
    v_cndmask_b32 v98, v197, v198, s[66:67]
    v_cndmask_b32 v99, v196, v197, s[66:67]
    v_cvt_pk_bf16_f32 v96, v98, v99
    v_cvt_pk_bf16_f32 v97, v196, v114
    v_cndmask_b32 v98, v194, v195, s[66:67]
    v_cndmask_b32 v99, v193, v194, s[66:67]
    v_cndmask_b32 v113, v192, v193, s[66:67]
    v_cndmask_b32 v112, v112, v192, s[66:67]
    v_cvt_pk_bf16_f32 v98, v98, v99
    v_cvt_pk_bf16_f32 v99, v113, v112
    s_nop 0
    v_permlane32_swap_b32 v98, v96
    v_permlane32_swap_b32 v99, v97
    ds_write_b128 v224, v[96:99] offset:4080
    s_waitcnt lgkmcnt(0)
    s_barrier
    s_cmp_lg_u32 s60, 0
    s_cbranch_scc1 L_hg
    v_lshlrev_b32 v65, 2, v1
    v_add_u32 v66, 102400, v65
    ds_read_b32 v68, v66
    ds_read_b32 v69, v66 offset:256
    ds_read_b32 v70, v66 offset:512
    ds_read_b32 v71, v66 offset:768
    s_waitcnt lgkmcnt(0)
    v_add_f32 v68, v68, v69
    v_add_f32 v70, v70, v71
    v_add_f32 v68, v68, v70
    v_cvt_pk_bf16_f32 v68, v68, v68
    v_lshlrev_b32 v68, 16, v68
    v_mul_f32 v68, 0xbfb8aa3b, v68
    v_exp_f32 v68, v68
    s_nop 0
    v_add_f32 v68, 1.0, v68
    v_rcp_f32 v68, v68
    s_nop 0
    v_cvt_pk_bf16_f32 v68, v68, v68
    v_lshlrev_b32 v68, 16, v68
    s_lshl_b32 s30, s64, 8
    s_add_u32 s30, s30, 16384
    buffer_store_dword v68, v65, s[16:19], s30 offen sc1
L_hg:
    s_mov_b32 s96, 0
    s_add_u32 m0, s92, 68608
    s_add_u32 m0, s92, 84992
    s_add_u32 m0, s92, 35840
    s_add_u32 m0, s92, 52224
    buffer_load_dword v63, v57, s[16:19], 0 offen sc1
    ds_read_b64_tr_b16 a[0:1], v38 offset:32768
    ds_read_b64_tr_b16 a[2:3], v38 offset:33792
    ds_read_b64_tr_b16 a[4:5], v39 offset:32768
    ds_read_b64_tr_b16 a[6:7], v39 offset:33792
    ds_read_b64_tr_b16 a[8:9], v38 offset:34816
    ds_read_b64_tr_b16 a[10:11], v38 offset:35840
    ds_read_b64_tr_b16 a[12:13], v39 offset:34816
    ds_read_b64_tr_b16 a[14:15], v39 offset:35840
    s_add_u32 m0, s92, 68608
    s_waitcnt lgkmcnt(0)
    buffer_load_dwordx4 v36, s[12:15], s36 offen offset:0 lds
    buffer_load_dwordx4 v37, s[12:15], s36 offen offset:1024 lds
    buffer_load_dwordx4 v28, s[12:15], s36 offen offset:2048 lds
    buffer_load_dwordx4 v42, s[12:15], s36 offen offset:3072 lds
    s_add_u32 m0, s93, 0
    s_waitcnt vmcnt(4)
    v_cmp_ne_u32 vcc, s63, v63
    s_nop 1
    s_cbranch_vccnz slow_19
ret_20:
    ds_write_b128 v60, v[240:243]
    s_mov_b32 s97, 0
    buffer_load_dwordx4 v32, s[16:19], s97 offen offset:0 sc1 lds
    buffer_load_dwordx4 v33, s[16:19], s97 offen offset:1024 sc1 lds
    buffer_load_dwordx4 v34, s[16:19], s97 offen offset:2048 sc1 lds
    buffer_load_dwordx4 v35, s[16:19], s97 offen offset:3072 sc1 lds
    s_add_u32 m0, s93, 4096
    s_mov_b32 s97, 1024
    buffer_load_dwordx4 v32, s[16:19], s97 offen offset:0 sc1 lds
    ds_read_b64_tr_b16 a[16:17], v38 offset:49152
    buffer_load_dwordx4 v33, s[16:19], s97 offen offset:1024 sc1 lds
    ds_read_b64_tr_b16 a[18:19], v38 offset:50176
    ds_read_b64_tr_b16 a[20:21], v39 offset:49152
    ds_read_b64_tr_b16 a[22:23], v39 offset:50176
    buffer_load_dwordx4 v34, s[16:19], s97 offen offset:2048 sc1 lds
    ds_read_b64_tr_b16 a[24:25], v38 offset:51200
    ds_read_b64_tr_b16 a[26:27], v38 offset:52224
    ds_read_b64_tr_b16 a[28:29], v39 offset:51200
    buffer_load_dwordx4 v35, s[16:19], s97 offen offset:3072 sc1 lds
    ds_read_b64_tr_b16 a[30:31], v39 offset:52224
    s_add_u32 m0, s92, 84992
    s_waitcnt lgkmcnt(0)
    buffer_load_dwordx4 v36, s[12:15], s37 offen offset:0 lds
    buffer_load_dwordx4 v37, s[12:15], s37 offen offset:1024 lds
    buffer_load_dwordx4 v28, s[12:15], s37 offen offset:2048 lds
    ds_read_b64_tr_b16 a[32:33], v38 offset:0
    ds_read_b64_tr_b16 a[34:35], v38 offset:1024
    ds_read_b64_tr_b16 a[36:37], v39 offset:0
    ds_read_b64_tr_b16 a[38:39], v39 offset:1024
    ds_read_b64_tr_b16 a[40:41], v38 offset:2048
    ds_read_b64_tr_b16 a[42:43], v38 offset:3072
    buffer_load_dwordx4 v42, s[12:15], s37 offen offset:3072 lds
    ds_read_b64_tr_b16 a[44:45], v39 offset:2048
    ds_read_b64_tr_b16 a[46:47], v39 offset:3072
    s_add_u32 m0, s92, 35840
    s_waitcnt lgkmcnt(0)
    buffer_load_dwordx4 v36, s[12:15], s38 offen offset:0 lds
    v_add_u32 v36, 32768, v36
    buffer_load_dwordx4 v37, s[12:15], s38 offen offset:1024 lds
    v_add_u32 v37, 32768, v37
    ds_read_b64_tr_b16 a[48:49], v38 offset:16384
    s_waitcnt vmcnt(6)
    ds_write_b32 v61, v26 offset:1664
    s_waitcnt lgkmcnt(0)
    s_barrier
    ds_read_b128 v[64:67], v23 offset:3584
    ds_read_b128 v[96:99], v24 offset:0
    ds_read_b64_tr_b16 a[50:51], v38 offset:17408
    ds_read_b128 v[68:71], v23 offset:3072
    ds_read_b128 v[100:103], v24 offset:2048
    ds_read_b64_tr_b16 a[52:53], v39 offset:16384
    ds_read_b128 v[72:75], v23 offset:2560
    ds_read_b128 v[104:107], v24 offset:4096
    buffer_load_dwordx4 v28, s[12:15], s38 offen offset:2048 lds
    v_add_u32 v28, 32768, v28
    ds_read_b64_tr_b16 a[54:55], v39 offset:17408
    ds_read_b128 v[76:79], v23 offset:2048
    ds_read_b128 v[108:111], v24 offset:6144
    ds_read_b64_tr_b16 a[56:57], v38 offset:18432
    ds_read_b128 v[80:83], v23 offset:1536
    ds_read_b128 v[112:115], v24 offset:8192
    ds_read_b64_tr_b16 a[58:59], v38 offset:19456
    ds_read_b128 v[84:87], v23 offset:1024
    ds_read_b128 v[116:119], v24 offset:10240
    ds_read_b64_tr_b16 a[60:61], v39 offset:18432
    ds_read_b128 v[88:91], v23 offset:512
    ds_read_b128 v[120:123], v24 offset:12288
    buffer_load_dwordx4 v42, s[12:15], s38 offen offset:3072 lds
    v_add_u32 v42, 32768, v42
    ds_read_b64_tr_b16 a[62:63], v39 offset:19456
    ds_read_b128 v[92:95], v23 offset:0
    ds_read_b128 v[124:127], v24 offset:14336
    s_lshl_b32 s30, s64, 10
    s_add_u32 s30, s30, 32924
    v_lshlrev_b32 v21, 8, v1
    s_cmp_lg_u32 s60, 0
    s_waitcnt vmcnt(0) lgkmcnt(0)
    s_cbranch_scc1 L_conv
    s_mov_b64 exec, 15
    buffer_store_dword v29, v21, s[16:19], s30 offen offset:0 sc1
    s_mov_b64 exec, -1
    s_branch L_conv
slow_1:
    s_mov_b32 s28, 0
sl_3:
    buffer_load_dwordx2 v[30:31], v26, s[24:27], 0 offen sc1
    s_waitcnt vmcnt(0)
    v_cmp_eq_u32 vcc, 0, v31
    s_add_u32 s28, s28, 1
    s_cmp_gt_u32 s28, 100000
    s_cbranch_scc1 ret_2
    s_cbranch_vccnz sl_3
    s_branch ret_2
slow_4:
    s_mov_b32 s28, 0
sl_6:
    s_sleep 8
    buffer_load_dword v63, v57, s[16:19], 0 offen sc1
    s_waitcnt vmcnt(0)
    v_cmp_ne_u32 vcc, s63, v63
    s_add_u32 s28, s28, 1
    s_cmp_gt_u32 s28, 100000
    s_cbranch_scc1 ret_5
    s_cbranch_vccnz sl_6
    s_branch ret_5
slow_7:
    s_mov_b32 s28, 0
sl_9:
    s_sleep 8
    buffer_load_dword v63, v58, s[16:19], 0 offen sc1
    s_waitcnt vmcnt(0)
    v_cmp_ne_u32 vcc, s63, v63
    s_add_u32 s28, s28, 1
    s_cmp_gt_u32 s28, 100000
    s_cbranch_scc1 ret_8
    s_cbranch_vccnz sl_9
    s_branch ret_8
slow_10:
    s_mov_b32 s28, 0
sl_12:
    s_sleep 8
    buffer_load_dword v41, v40, s[16:19], 0 offen sc1
    s_waitcnt vmcnt(0)
    v_cmp_ne_u32 vcc, s63, v41
    s_add_u32 s28, s28, 1
    s_cmp_gt_u32 s28, 100000
    s_cbranch_scc1 ret_11
    s_cbranch_vccnz sl_12
    s_branch ret_11
slow_13:
    s_mov_b32 s28, 0
sl_15:
    s_sleep 8
    buffer_load_dword v63, v59, s[16:19], 0 offen sc1
    s_waitcnt vmcnt(0)
    v_cmp_ne_u32 vcc, s63, v63
    s_add_u32 s28, s28, 1
    s_cmp_gt_u32 s28, 100000
    s_cbranch_scc1 ret_14
    s_cbranch_vccnz sl_15
    s_branch ret_14
slow_16:
    s_mov_b32 s28, 0
sl_18:
    buffer_load_dwordx2 v[30:31], v26, s[24:27], 0 offen sc1
    s_waitcnt vmcnt(0)
    v_cmp_eq_u32 vcc, 0, v31
    s_add_u32 s28, s28, 1
    s_cmp_gt_u32 s28, 100000
    s_cbranch_scc1 ret_17
    s_cbranch_vccnz sl_18
    s_branch ret_17
slow_19:
    s_mov_b32 s28, 0
sl_21:
    s_sleep 8
    buffer_load_dword v63, v57, s[16:19], 0 offen sc1
    s_waitcnt vmcnt(0)
    v_cmp_ne_u32 vcc, s63, v63
    s_add_u32 s28, s28, 1
    s_cmp_gt_u32 s28, 100000
    s_cbranch_scc1 ret_20
    s_cbranch_vccnz sl_21
    s_branch ret_20
L_end:
    s_endpgm
.section .rodata,"a"
.p2align 6
.amdhsa_kernel gated_mix__ssm_conv_s4d__dense_activation_silu__prompt_kernel
  .amdhsa_next_free_vgpr 512
  .amdhsa_next_free_sgpr 102
  .amdhsa_accum_offset 256
  .amdhsa_group_segment_fixed_size 0
  .amdhsa_kernarg_size 112
  .amdhsa_user_sgpr_count 2
  .amdhsa_user_sgpr_kernarg_segment_ptr 1
  .amdhsa_system_sgpr_workgroup_id_x 1
.end_amdhsa_kernel
```
